```python
import torch

def _softmax(x, axis=-1):
    return torch.softmax(x, dim=axis)
def _gelu(x):
    return torch.nn.functional.gelu(x, approximate="tanh")
def _silu(x):
    return torch.nn.functional.silu(x)
def _sigmoid(x):
    return torch.sigmoid(x)
def _layernorm(x, axis=-1, eps=1e-5):
    m = x.mean(dim=axis, keepdim=True)
    v = x.var(dim=axis, keepdim=True, unbiased=False)
    return (x - m) / torch.sqrt(v + eps)
def _scatter_add(tgt, idx, src, axis=0):
    return tgt.clone().index_add_(axis, idx, src)
def _segment_sum(src, seg, n):
    out = torch.zeros((n,) + src.shape[1:], dtype=src.dtype)
    return out.index_add_(0, seg, src)
def _pad(x, pw):
    flat = tuple(v for pair in reversed(pw) for v in pair)
    return torch.nn.functional.pad(x, flat)

kernel_name = 'standalone__dense_activation_squared_relu__prompt'

def setup_inputs():

    _w = (lambda a: (lambda t: t.to(torch.bfloat16) if t.is_floating_point() else t)(torch.as_tensor(a)))
    B, S, D, F = 1, 2048, 512, 1792
    return {
        "x": _w((lambda *s: torch.randn(*s, dtype=torch.bfloat16) * 0.05)(B, S, D)),
        "w1": _w((lambda *s: torch.randn(*s, dtype=torch.bfloat16) * 0.05)(D, F)),
        "b1": _w((lambda *s: torch.randn(*s, dtype=torch.bfloat16) * 0.05)(F)),
        "w2": _w((lambda *s: torch.randn(*s, dtype=torch.bfloat16) * 0.05)(F, D)),
        "b2": _w((lambda *s: torch.randn(*s, dtype=torch.bfloat16) * 0.05)(D)),
    }

def reference(x, w1, b1, w2, b2):
    h = torch.einsum("bsd,df->bsf", x, w1) + b1
    zero = torch.zeros_like(h)
    r = torch.where(h > zero, h, zero)
    h = r * r
    out = torch.einsum("bsf,fd->bsd", h, w2) + b2
    return out
```

```asm
; @launch grid=(256,1,1) block=(256,1,1) lds=163840
.amdgcn_target "amdgcn-amd-amdhsa--gfx950"
.text
.globl standalone__dense_activation_squared_relu__prompt_kernel
.p2align 8
.type standalone__dense_activation_squared_relu__prompt_kernel,@function
standalone__dense_activation_squared_relu__prompt_kernel:
    s_load_dwordx16 s[4:19], s[0:1], 0
    s_cmp_ge_u32 s2, 224
    s_cbranch_scc1 L_idle0
    v_readfirstlane_b32 s20, v0
    v_and_b32 v1, 63, v0
    s_lshr_b32 s22, s2, 3
    s_and_b32 s21, s2, 7
    v_lshrrev_b32 v2, 3, v1
    v_lshrrev_b32 v3, 4, v1
    v_and_b32 v4, 7, v1
    s_lshr_b32 s20, s20, 6
    v_xor_b32 v5, v4, v3
    v_lshlrev_b32 v5, 4, v5
    v_lshl_add_u32 v12, v2, 10, v5
    s_and_b32 s44, s21, 3
    s_lshl_b32 s44, s44, 2
    s_and_b32 s23, s22, 3
    s_add_u32 s44, s44, s23
    s_lshr_b32 s45, s22, 2
    s_add_u32 s49, s45, s23
    v_xor_b32 v13, 64, v12
    s_lshl_b32 s50, s44, 2
    s_add_u32 s50, s50, s20
    s_lshl_b32 s50, s50, 15
    s_lshl_b32 s52, s20, 12
    v_add_u32 v13, 7168, v13
    v_add_u32 v14, 14336, v12
    v_add_u32 v15, 14336, v13
    s_and_b32 s60, s49, 1
    s_mov_b32 s26, 2097152
    s_mov_b32 s27, 0x20000
    s_mov_b32 m0, s52
    s_lshl_b32 s53, s60, 7
    s_add_u32 s53, s53, s50
    s_lshr_b32 s23, s21, 2
    s_mul_i32 s23, s23, 7
    s_add_u32 s45, s45, s23
    v_and_b32 v4, 15, v1
    v_lshlrev_b32 v5, 1, v3
    v_xor_b32 v4, v4, v5
    v_lshlrev_b32 v4, 4, v4
    s_waitcnt lgkmcnt(0)
    s_mov_b32 s24, s4
    s_and_b32 s25, s5, 0xffff
    buffer_load_dwordx4 v12, s[24:27], s53 offen offset:0 lds
    buffer_load_dwordx4 v13, s[24:27], s53 offen offset:1024 lds
    buffer_load_dwordx4 v14, s[24:27], s53 offen offset:2048 lds
    buffer_load_dwordx4 v15, s[24:27], s53 offen offset:3072 lds
    v_mul_u32_u24 v5, 3584, v3
    v_add_u32 v16, v4, v5
    v_xor_b32 v4, 128, v4
    v_add_u32 v4, v4, v5
    v_add_u32 v17, 13312, v16
    v_add_u32 v18, 26624, v4
    v_add_u32 v19, 39936, v4
    s_mul_i32 s51, s20, 57344
    s_lshl_b32 s23, s45, 8
    s_add_u32 s51, s51, s23
    s_mov_b32 s28, s6
    s_and_b32 s29, s7, 0xffff
    s_mov_b32 s30, 1835008
    s_mov_b32 s31, 0x20000
    s_mul_i32 s53, s60, 229376
    s_add_u32 m0, s52, 16384
    s_add_u32 s53, s53, s51
    buffer_load_dwordx4 v16, s[28:31], s53 offen offset:0 lds
    buffer_load_dwordx4 v17, s[28:31], s53 offen offset:1024 lds
    buffer_load_dwordx4 v18, s[28:31], s53 offen offset:2048 lds
    buffer_load_dwordx4 v19, s[28:31], s53 offen offset:3072 lds
    s_lshr_b32 s53, s20, 1
    s_lshl_b32 s53, s53, 7
    s_add_u32 s23, s23, s53
    v_lshl_add_u32 v6, v3, 3, s23
    global_load_dwordx2 v[48:49], v6, s[8:9] offset:0
    global_load_dwordx2 v[50:51], v6, s[8:9] offset:32
    global_load_dwordx2 v[52:53], v6, s[8:9] offset:64
    global_load_dwordx2 v[54:55], v6, s[8:9] offset:96
    v_lshlrev_b32 v11, 4, v1
    s_mov_b32 s32, s10
    s_and_b32 s33, s11, 0xffff
    s_mov_b32 s34, 1835008
    s_mov_b32 s35, 0x20000
    s_mov_b32 s36, s18
    s_and_b32 s37, s19, 0xffff
    s_mov_b32 s38, 7536640
    s_mov_b32 s39, 0x20000
    s_mov_b32 s40, s14
    s_and_b32 s41, s15, 0xffff
    s_mov_b32 s42, 2097152
    s_mov_b32 s43, 0x20000
    s_xor_b32 s4, s60, 0
    s_xor_b32 s5, s60, 1
    s_lshl_b32 s53, s5, 7
    s_add_u32 m0, s52, 32768
    s_add_u32 s53, s53, s50
    buffer_load_dwordx4 v12, s[24:27], s53 offen offset:0 lds
    buffer_load_dwordx4 v13, s[24:27], s53 offen offset:1024 lds
    s_branch L_act
L_idle0:
    s_cmp_ge_u32 s2, 256
    s_cbranch_scc1 L_end
    v_readfirstlane_b32 s20, v0
    v_and_b32 v1, 63, v0
    s_lshr_b32 s22, s2, 3
    s_and_b32 s21, s2, 7
    s_lshr_b32 s20, s20, 6
    s_getpc_b64 s[60:61]
L_pc:
    s_sub_u32 s60, s60, L_pc-standalone__dense_activation_squared_relu__prompt_kernel
    s_subb_u32 s61, s61, 0
    s_sub_u32 s23, s22, 28
    s_lshl_b32 s23, s23, 12
    v_lshl_add_u32 v2, v0, 4, s23
    v_and_b32 v2, 0xffffffc0, v2
    v_min_u32 v2, L_end-standalone__dense_activation_squared_relu__prompt_kernel, v2
    global_load_dword v59, v2, s[60:61]
    s_waitcnt lgkmcnt(0)
    s_mov_b32 s24, s4
    s_and_b32 s25, s5, 0xffff
    s_mov_b32 s26, 2097152
    s_mov_b32 s27, 0x20000
    s_mov_b32 s28, s6
    s_and_b32 s29, s7, 0xffff
    s_mov_b32 s30, 1835008
    s_mov_b32 s31, 0x20000
    v_lshlrev_b32 v11, 4, v1
    s_mov_b32 s32, s10
    s_and_b32 s33, s11, 0xffff
    s_mov_b32 s34, 1835008
    s_mov_b32 s35, 0x20000
    s_mov_b32 s36, s18
    s_and_b32 s37, s19, 0xffff
    s_mov_b32 s38, 7536640
    s_mov_b32 s39, 0x20000
    s_mov_b32 s40, s14
    s_and_b32 s41, s15, 0xffff
    s_mov_b32 s42, 2097152
    s_mov_b32 s43, 0x20000
    s_cmp_lg_u32 s2, 224
    s_cbranch_scc1 L_nopub
    s_cmp_lg_u32 s20, 0
    s_cbranch_scc1 L_fl
    v_mov_b32 v32, 7471104
    global_load_dword v33, v32, s[18:19]
    v_mov_b32 v31, 0
    s_waitcnt vmcnt(0)
    v_add_u32 v33, 0x2468ace, v33
    v_or_b32 v33, 1, v33
    s_mov_b64 exec, 1
    global_store_dword v31, v33, s[16:17] sc1
    global_store_dword v32, v33, s[18:19] sc1
    s_mov_b64 exec, -1
    s_branch L_nopub
L_fl:
    s_cmp_lt_u32 s20, 2
    s_cbranch_scc1 L_nopub
    v_lshlrev_b32 v32, 7, v0
    v_add_u32 v32, 7323648, v32
    global_load_dword v33, v32, s[18:19]
L_nopub:
    s_sub_u32 s60, s22, 28
    s_lshl_b32 s60, s60, 2
    s_add_u32 s60, s60, s20
    s_and_b32 s23, s21, 3
    s_lshl_b32 s61, s23, 19
    s_lshr_b32 s55, s21, 2
    s_lshl_b32 s53, s55, 18
    s_add_u32 s61, s61, s53
    s_lshl_b32 s53, s60, 14
    s_add_u32 s61, s61, s53
    v_and_b32 v35, 15, v1
    v_lshlrev_b32 v35, 10, v35
    s_lshl_b32 s53, s60, 2
    s_add_u32 s53, s53, s23
    s_mul_i32 s53, s53, 3584
    s_mul_i32 s55, s55, 1792
    s_add_u32 s55, s55, s53
    v_min_u32 v36, 13, v1
    v_lshlrev_b32 v36, 7, v36
    s_add_u32 s53, s55, 458752
    buffer_load_dword v40, v35, s[24:27], s61 offen offset:256
    buffer_load_dword v41, v36, s[28:31], s53 offen
    s_add_u32 s53, s55, 688128
    buffer_load_dword v40, v35, s[24:27], s61 offen offset:384
    buffer_load_dword v41, v36, s[28:31], s53 offen
    s_add_u32 s53, s55, 917504
    buffer_load_dword v40, v35, s[24:27], s61 offen offset:512
    buffer_load_dword v41, v36, s[28:31], s53 offen
    s_add_u32 s53, s55, 1146880
    buffer_load_dword v40, v35, s[24:27], s61 offen offset:640
    buffer_load_dword v41, v36, s[28:31], s53 offen
    s_add_u32 s53, s55, 1376256
    buffer_load_dword v40, v35, s[24:27], s61 offen offset:768
    buffer_load_dword v41, v36, s[28:31], s53 offen
    s_add_u32 s53, s55, 1605632
    buffer_load_dword v40, v35, s[24:27], s61 offen offset:896
    buffer_load_dword v41, v36, s[28:31], s53 offen
    s_branch L_idle2
L_act:
    s_and_b32 s60, s49, 1
    s_xor_b32 s6, s60, 2
    v_and_b32 v2, 15, v1
    v_lshrrev_b32 v3, 4, v1
    v_bfe_u32 v4, v1, 1, 3
    s_and_b32 s23, s20, 1
    s_lshl_b32 s23, s23, 13
    v_lshl_add_u32 v5, v2, 7, s23
    v_or_b32 v7, 0, v3
    v_xor_b32 v7, v7, v4
    v_lshl_add_u32 v224, v7, 4, v5
    v_or_b32 v7, 4, v3
    v_xor_b32 v7, v7, v4
    v_lshl_add_u32 v225, v7, 4, v5
    v_bfe_u32 v2, v1, 2, 2
    v_and_b32 v4, 3, v1
    v_bfe_u32 v5, v1, 4, 1
    v_lshl_add_u32 v7, v3, 3, v2
    v_lshlrev_b32 v7, 8, v7
    v_lshl_add_u32 v7, v4, 3, v7
    v_lshl_or_b32 v5, v5, 2, v2
    s_and_b32 s23, s20, 2
    s_lshl_b32 s23, s23, 1
    s_or_b32 s55, s23, 0
    v_xor_b32 v8, s55, v5
    v_lshl_add_u32 v230, v8, 5, v7
    s_or_b32 s55, s23, 1
    v_xor_b32 v8, s55, v5
    v_lshl_add_u32 v231, v8, 5, v7
    s_or_b32 s55, s23, 2
    v_xor_b32 v8, s55, v5
    v_lshl_add_u32 v232, v8, 5, v7
    s_or_b32 s55, s23, 3
    v_xor_b32 v8, s55, v5
    v_lshl_add_u32 v233, v8, 5, v7
    v_add_u32 v226, 65536, v224
    v_add_u32 v227, 65536, v225
    v_add_u32 v234, 65536, v230
    v_add_u32 v235, 65536, v231
    v_add_u32 v236, 65536, v232
    v_add_u32 v237, 65536, v233
    v_add_u32 v228, 131072, v224
    v_add_u32 v229, 131072, v225
    v_add_u32 v238, 131072, v230
    v_add_u32 v239, 131072, v231
    v_add_u32 v240, 131072, v232
    v_add_u32 v241, 131072, v233
    s_and_b32 s46, s21, 3
    s_lshl_b32 s46, s46, 3
    s_lshr_b32 s23, s21, 2
    s_lshl_b32 s23, s23, 2
    s_add_u32 s46, s46, s23
    s_mul_i32 s23, s22, 37
    s_lshr_b32 s23, s23, 8
    s_mul_i32 s47, s23, 7
    s_sub_u32 s47, s22, s47
    s_cmp_ge_u32 s47, 3
    s_addc_u32 s47, s47, 0
    s_add_u32 s46, s46, s23
    s_add_u32 s63, s23, s47
    s_mul_i32 s62, s21, 7
    s_lshr_b32 s62, s62, 2
    s_lshl_b32 s62, s62, 10
    s_lshl_b32 s23, s47, 7
    v_and_b32 v9, 15, v0
    v_lshl_add_u32 v9, v9, 3, s23
    global_load_dwordx2 v[60:61], v9, s[12:13]
    s_xor_b32 s7, s60, 3
    s_and_b32 s60, s49, 1
    s_xor_b32 s10, s60, 4
    s_xor_b32 s11, s60, 5
    s_and_b32 s60, s49, 1
    s_xor_b32 s14, s60, 6
    s_xor_b32 s15, s60, 7
    v_lshrrev_b32 v2, 3, v1
    v_lshrrev_b32 v3, 4, v1
    v_and_b32 v4, 7, v1
    v_lshlrev_b32 v5, 1, v3
    v_xor_b32 v4, v4, v5
    v_lshlrev_b32 v4, 4, v4
    v_lshl_add_u32 v20, v2, 10, v4
    v_add_u32 v21, 7168, v20
    v_add_u32 v22, 14336, v20
    v_add_u32 v23, 21504, v20
    s_mul_i32 s56, s20, 458752
    s_lshl_b32 s23, s47, 7
    s_add_u32 s56, s56, s23
    s_lshl_b32 s57, s20, 13
    s_and_b32 s61, s63, 1
    s_mul_i32 s61, s61, 3072
    s_add_u32 s64, s61, 0
    s_add_u32 s65, s64, 1024
    s_cmp_eq_u32 s65, 6144
    s_cselect_b32 s65, 0, s65
    s_add_u32 s66, s65, 1024
    s_cmp_eq_u32 s66, 6144
    s_cselect_b32 s66, 0, s66
    s_add_u32 s67, s66, 1024
    s_cmp_eq_u32 s67, 6144
    s_cselect_b32 s67, 0, s67
    s_add_u32 s68, s67, 1024
    s_cmp_eq_u32 s68, 6144
    s_cselect_b32 s68, 0, s68
    s_add_u32 s69, s68, 1024
    s_cmp_eq_u32 s69, 6144
    s_cselect_b32 s69, 0, s69
    s_add_u32 s64, s64, s62
    s_sub_u32 s23, s64, 14336
    s_cselect_b32 s64, s64, s23
    s_add_u32 s65, s65, s62
    s_sub_u32 s23, s65, 14336
    s_cselect_b32 s65, s65, s23
    s_add_u32 s66, s66, s62
    s_sub_u32 s23, s66, 14336
    s_cselect_b32 s66, s66, s23
    s_add_u32 s67, s67, s62
    s_sub_u32 s23, s67, 14336
    s_cselect_b32 s67, s67, s23
    s_add_u32 s68, s68, s62
    s_sub_u32 s23, s68, 14336
    s_cselect_b32 s68, s68, s23
    s_add_u32 s69, s69, s62
    s_sub_u32 s23, s69, 14336
    s_cselect_b32 s69, s69, s23
    v_mov_b32 v31, 0
    v_add_u32 v27, 57344, v11
    v_add_u32 v28, 114688, v11
    v_add_u32 v29, 172032, v11
    s_and_b32 s60, s20, 1
    s_lshl_b32 s61, s44, 1
    s_add_u32 s60, s60, s61
    s_lshr_b32 s23, s20, 1
    s_lshl_b32 s55, s45, 1
    s_add_u32 s23, s23, s55
    s_mul_i32 s54, s60, 229376
    s_lshl_b32 s55, s23, 11
    s_add_u32 s54, s54, s55
    s_mul_i32 s55, s23, 37
    s_lshr_b32 s55, s55, 8
    s_mul_i32 s61, s55, 7
    s_sub_u32 s23, s23, s61
    s_lshl_b32 s60, s60, 2
    s_add_u32 s60, s60, s55
    s_lshl_b32 s60, s60, 5
    s_add_u32 s60, s60, s23
    s_lshl_b32 s60, s60, 2
    s_add_u32 s44, s60, 7340032
    buffer_load_dwordx4 v14, s[24:27], s53 offen offset:2048 lds
    buffer_load_dwordx4 v15, s[24:27], s53 offen offset:3072 lds
    s_mul_i32 s53, s5, 229376
    s_add_u32 m0, s52, 49152
    s_add_u32 s53, s53, s51
    buffer_load_dwordx4 v16, s[28:31], s53 offen offset:0 lds
    buffer_load_dwordx4 v17, s[28:31], s53 offen offset:1024 lds
    buffer_load_dwordx4 v18, s[28:31], s53 offen offset:2048 lds
    buffer_load_dwordx4 v19, s[28:31], s53 offen offset:3072 lds
    s_lshl_b32 s53, s6, 7
    s_add_u32 m0, s52, 65536
    s_add_u32 s53, s53, s50
    buffer_load_dwordx4 v12, s[24:27], s53 offen offset:0 lds
    buffer_load_dwordx4 v13, s[24:27], s53 offen offset:1024 lds
    buffer_load_dwordx4 v14, s[24:27], s53 offen offset:2048 lds
    buffer_load_dwordx4 v15, s[24:27], s53 offen offset:3072 lds
    s_waitcnt vmcnt(17)
    s_barrier
    ds_read_b128 v[144:147], v224 offset:0
    ds_read_b64_tr_b16 v[128:129], v230 offset:16384
    ds_read_b64_tr_b16 v[130:131], v230 offset:17408
    ds_read_b128 v[148:151], v224 offset:2048
    ds_read_b128 v[152:155], v224 offset:4096
    ds_read_b128 v[156:159], v224 offset:6144
    ds_read_b64_tr_b16 v[132:133], v231 offset:16384
    ds_read_b64_tr_b16 v[134:135], v231 offset:17408
    ds_read_b64_tr_b16 v[136:137], v232 offset:16384
    ds_read_b64_tr_b16 v[138:139], v232 offset:17408
    ds_read_b64_tr_b16 v[140:141], v233 offset:16384
    ds_read_b64_tr_b16 v[142:143], v233 offset:17408
    s_waitcnt vmcnt(13)
    v_lshlrev_b32 v32, 16, v48
    v_and_b32 v33, 0xffff0000, v48
    v_lshlrev_b32 v34, 16, v49
    v_and_b32 v35, 0xffff0000, v49
    v_lshlrev_b32 v36, 16, v50
    v_and_b32 v37, 0xffff0000, v50
    v_lshlrev_b32 v38, 16, v51
    v_and_b32 v39, 0xffff0000, v51
    v_lshlrev_b32 v40, 16, v52
    v_and_b32 v41, 0xffff0000, v52
    v_lshlrev_b32 v42, 16, v53
    v_and_b32 v43, 0xffff0000, v53
    v_lshlrev_b32 v44, 16, v54
    v_and_b32 v45, 0xffff0000, v54
    v_lshlrev_b32 v46, 16, v55
    v_and_b32 v47, 0xffff0000, v55
    s_waitcnt lgkmcnt(4)
    v_mfma_f32_16x16x32_bf16 v[64:67], v[128:131], v[144:147], v[32:35]
    ds_read_b128 v[176:179], v225 offset:0
    s_mul_i32 s53, s6, 229376
    s_add_u32 m0, s52, 81920
    s_add_u32 s53, s53, s51
    buffer_load_dwordx4 v16, s[28:31], s53 offen offset:0 lds
    v_mfma_f32_16x16x32_bf16 v[68:71], v[128:131], v[148:151], v[32:35]
    ds_read_b64_tr_b16 v[160:161], v230 offset:24576
    buffer_load_dwordx4 v17, s[28:31], s53 offen offset:1024 lds
    v_mfma_f32_16x16x32_bf16 v[72:75], v[128:131], v[152:155], v[32:35]
    ds_read_b64_tr_b16 v[162:163], v230 offset:25600
    buffer_load_dwordx4 v18, s[28:31], s53 offen offset:2048 lds
    v_mfma_f32_16x16x32_bf16 v[76:79], v[128:131], v[156:159], v[32:35]
    ds_read_b128 v[180:183], v225 offset:2048
    buffer_load_dwordx4 v19, s[28:31], s53 offen offset:3072 lds
    v_mfma_f32_16x16x32_bf16 v[92:95], v[132:135], v[156:159], v[36:39]
    ds_read_b128 v[184:187], v225 offset:4096
    s_lshl_b32 s53, s7, 7
    v_mfma_f32_16x16x32_bf16 v[88:91], v[132:135], v[152:155], v[36:39]
    ds_read_b128 v[188:191], v225 offset:6144
    s_add_u32 m0, s52, 98304
    v_mfma_f32_16x16x32_bf16 v[84:87], v[132:135], v[148:151], v[36:39]
    ds_read_b64_tr_b16 v[164:165], v231 offset:24576
    s_add_u32 s53, s53, s50
    buffer_load_dwordx4 v12, s[24:27], s53 offen offset:0 lds
    v_mfma_f32_16x16x32_bf16 v[80:83], v[132:135], v[144:147], v[36:39]
    ds_read_b64_tr_b16 v[166:167], v231 offset:25600
    s_waitcnt lgkmcnt(8)
    v_mfma_f32_16x16x32_bf16 v[96:99], v[136:139], v[144:147], v[40:43]
    ds_read_b64_tr_b16 v[168:169], v232 offset:24576
    v_mfma_f32_16x16x32_bf16 v[100:103], v[136:139], v[148:151], v[40:43]
    ds_read_b64_tr_b16 v[170:171], v232 offset:25600
    v_mfma_f32_16x16x32_bf16 v[104:107], v[136:139], v[152:155], v[40:43]
    ds_read_b64_tr_b16 v[172:173], v233 offset:24576
    buffer_load_dwordx4 v13, s[24:27], s53 offen offset:1024 lds
    v_mfma_f32_16x16x32_bf16 v[108:111], v[136:139], v[156:159], v[40:43]
    ds_read_b64_tr_b16 v[174:175], v233 offset:25600
    v_mfma_f32_16x16x32_bf16 v[124:127], v[140:143], v[156:159], v[44:47]
    v_mfma_f32_16x16x32_bf16 v[120:123], v[140:143], v[152:155], v[44:47]
    v_mfma_f32_16x16x32_bf16 v[116:119], v[140:143], v[148:151], v[44:47]
    buffer_load_dwordx4 v14, s[24:27], s53 offen offset:2048 lds
    v_mfma_f32_16x16x32_bf16 v[112:115], v[140:143], v[144:147], v[44:47]
    s_waitcnt vmcnt(11)
    s_barrier
    s_waitcnt lgkmcnt(4)
    v_mfma_f32_16x16x32_bf16 v[64:67], v[160:163], v[176:179], v[64:67]
    ds_read_b128 v[144:147], v224 offset:32768
    v_mfma_f32_16x16x32_bf16 v[68:71], v[160:163], v[180:183], v[68:71]
    ds_read_b64_tr_b16 v[128:129], v230 offset:49152
    v_mfma_f32_16x16x32_bf16 v[72:75], v[160:163], v[184:187], v[72:75]
    ds_read_b64_tr_b16 v[130:131], v230 offset:50176
    buffer_load_dwordx4 v15, s[24:27], s53 offen offset:3072 lds
    v_mfma_f32_16x16x32_bf16 v[76:79], v[160:163], v[188:191], v[76:79]
    ds_read_b128 v[148:151], v224 offset:34816
    s_mul_i32 s53, s7, 229376
    v_mfma_f32_16x16x32_bf16 v[92:95], v[164:167], v[188:191], v[92:95]
    ds_read_b128 v[152:155], v224 offset:36864
    s_add_u32 m0, s52, 114688
    v_mfma_f32_16x16x32_bf16 v[88:91], v[164:167], v[184:187], v[88:91]
    ds_read_b128 v[156:159], v224 offset:38912
    s_add_u32 s53, s53, s51
    v_mfma_f32_16x16x32_bf16 v[84:87], v[164:167], v[180:183], v[84:87]
    ds_read_b64_tr_b16 v[132:133], v231 offset:49152
    buffer_load_dwordx4 v16, s[28:31], s53 offen offset:0 lds
    v_mfma_f32_16x16x32_bf16 v[80:83], v[164:167], v[176:179], v[80:83]
    ds_read_b64_tr_b16 v[134:135], v231 offset:50176
    s_waitcnt lgkmcnt(8)
    v_mfma_f32_16x16x32_bf16 v[96:99], v[168:171], v[176:179], v[96:99]
    ds_read_b64_tr_b16 v[136:137], v232 offset:49152
    v_mfma_f32_16x16x32_bf16 v[100:103], v[168:171], v[180:183], v[100:103]
    ds_read_b64_tr_b16 v[138:139], v232 offset:50176
    v_mfma_f32_16x16x32_bf16 v[104:107], v[168:171], v[184:187], v[104:107]
    ds_read_b64_tr_b16 v[140:141], v233 offset:49152
    buffer_load_dwordx4 v17, s[28:31], s53 offen offset:1024 lds
    v_mfma_f32_16x16x32_bf16 v[108:111], v[168:171], v[188:191], v[108:111]
    ds_read_b64_tr_b16 v[142:143], v233 offset:50176
    v_mfma_f32_16x16x32_bf16 v[124:127], v[172:175], v[188:191], v[124:127]
    v_mfma_f32_16x16x32_bf16 v[120:123], v[172:175], v[184:187], v[120:123]
    v_mfma_f32_16x16x32_bf16 v[116:119], v[172:175], v[180:183], v[116:119]
    buffer_load_dwordx4 v18, s[28:31], s53 offen offset:2048 lds
    v_mfma_f32_16x16x32_bf16 v[112:115], v[172:175], v[176:179], v[112:115]
    s_waitcnt lgkmcnt(4)
    v_mfma_f32_16x16x32_bf16 v[64:67], v[128:131], v[144:147], v[64:67]
    ds_read_b128 v[176:179], v225 offset:32768
    v_mfma_f32_16x16x32_bf16 v[68:71], v[128:131], v[148:151], v[68:71]
    ds_read_b64_tr_b16 v[160:161], v230 offset:57344
    v_mfma_f32_16x16x32_bf16 v[72:75], v[128:131], v[152:155], v[72:75]
    ds_read_b64_tr_b16 v[162:163], v230 offset:58368
    buffer_load_dwordx4 v19, s[28:31], s53 offen offset:3072 lds
    v_mfma_f32_16x16x32_bf16 v[76:79], v[128:131], v[156:159], v[76:79]
    ds_read_b128 v[180:183], v225 offset:34816
    s_lshl_b32 s53, s10, 7
    v_mfma_f32_16x16x32_bf16 v[92:95], v[132:135], v[156:159], v[92:95]
    ds_read_b128 v[184:187], v225 offset:36864
    s_add_u32 m0, s52, 131072
    v_mfma_f32_16x16x32_bf16 v[88:91], v[132:135], v[152:155], v[88:91]
    ds_read_b128 v[188:191], v225 offset:38912
    s_add_u32 s53, s53, s50
    v_mfma_f32_16x16x32_bf16 v[84:87], v[132:135], v[148:151], v[84:87]
    ds_read_b64_tr_b16 v[164:165], v231 offset:57344
    buffer_load_dwordx4 v12, s[24:27], s53 offen offset:0 lds
    v_mfma_f32_16x16x32_bf16 v[80:83], v[132:135], v[144:147], v[80:83]
    ds_read_b64_tr_b16 v[166:167], v231 offset:58368
    s_waitcnt lgkmcnt(8)
    v_mfma_f32_16x16x32_bf16 v[96:99], v[136:139], v[144:147], v[96:99]
    ds_read_b64_tr_b16 v[168:169], v232 offset:57344
    v_mfma_f32_16x16x32_bf16 v[100:103], v[136:139], v[148:151], v[100:103]
    ds_read_b64_tr_b16 v[170:171], v232 offset:58368
    v_mfma_f32_16x16x32_bf16 v[104:107], v[136:139], v[152:155], v[104:107]
    ds_read_b64_tr_b16 v[172:173], v233 offset:57344
    buffer_load_dwordx4 v13, s[24:27], s53 offen offset:1024 lds
    v_mfma_f32_16x16x32_bf16 v[108:111], v[136:139], v[156:159], v[108:111]
    ds_read_b64_tr_b16 v[174:175], v233 offset:58368
    v_mfma_f32_16x16x32_bf16 v[124:127], v[140:143], v[156:159], v[124:127]
    v_mfma_f32_16x16x32_bf16 v[120:123], v[140:143], v[152:155], v[120:123]
    v_mfma_f32_16x16x32_bf16 v[116:119], v[140:143], v[148:151], v[116:119]
    buffer_load_dwordx4 v14, s[24:27], s53 offen offset:2048 lds
    v_mfma_f32_16x16x32_bf16 v[112:115], v[140:143], v[144:147], v[112:115]
    s_waitcnt vmcnt(11)
    s_barrier
    s_waitcnt lgkmcnt(4)
    v_mfma_f32_16x16x32_bf16 v[64:67], v[160:163], v[176:179], v[64:67]
    ds_read_b128 v[144:147], v226 offset:0
    v_mfma_f32_16x16x32_bf16 v[68:71], v[160:163], v[180:183], v[68:71]
    ds_read_b64_tr_b16 v[128:129], v234 offset:16384
    v_mfma_f32_16x16x32_bf16 v[72:75], v[160:163], v[184:187], v[72:75]
    ds_read_b64_tr_b16 v[130:131], v234 offset:17408
    buffer_load_dwordx4 v15, s[24:27], s53 offen offset:3072 lds
    v_mfma_f32_16x16x32_bf16 v[76:79], v[160:163], v[188:191], v[76:79]
    ds_read_b128 v[148:151], v226 offset:2048
    s_mul_i32 s53, s10, 229376
    v_mfma_f32_16x16x32_bf16 v[92:95], v[164:167], v[188:191], v[92:95]
    ds_read_b128 v[152:155], v226 offset:4096
    s_add_u32 m0, s52, 147456
    v_mfma_f32_16x16x32_bf16 v[88:91], v[164:167], v[184:187], v[88:91]
    ds_read_b128 v[156:159], v226 offset:6144
    s_add_u32 s53, s53, s51
    v_mfma_f32_16x16x32_bf16 v[84:87], v[164:167], v[180:183], v[84:87]
    ds_read_b64_tr_b16 v[132:133], v235 offset:16384
    buffer_load_dwordx4 v16, s[28:31], s53 offen offset:0 lds
    v_mfma_f32_16x16x32_bf16 v[80:83], v[164:167], v[176:179], v[80:83]
    ds_read_b64_tr_b16 v[134:135], v235 offset:17408
    s_waitcnt lgkmcnt(8)
    v_mfma_f32_16x16x32_bf16 v[96:99], v[168:171], v[176:179], v[96:99]
    ds_read_b64_tr_b16 v[136:137], v236 offset:16384
    v_mfma_f32_16x16x32_bf16 v[100:103], v[168:171], v[180:183], v[100:103]
    ds_read_b64_tr_b16 v[138:139], v236 offset:17408
    v_mfma_f32_16x16x32_bf16 v[104:107], v[168:171], v[184:187], v[104:107]
    ds_read_b64_tr_b16 v[140:141], v237 offset:16384
    buffer_load_dwordx4 v17, s[28:31], s53 offen offset:1024 lds
    v_mfma_f32_16x16x32_bf16 v[108:111], v[168:171], v[188:191], v[108:111]
    ds_read_b64_tr_b16 v[142:143], v237 offset:17408
    v_mfma_f32_16x16x32_bf16 v[124:127], v[172:175], v[188:191], v[124:127]
    v_mfma_f32_16x16x32_bf16 v[120:123], v[172:175], v[184:187], v[120:123]
    v_mfma_f32_16x16x32_bf16 v[116:119], v[172:175], v[180:183], v[116:119]
    buffer_load_dwordx4 v18, s[28:31], s53 offen offset:2048 lds
    v_mfma_f32_16x16x32_bf16 v[112:115], v[172:175], v[176:179], v[112:115]
    s_waitcnt lgkmcnt(4)
    v_mfma_f32_16x16x32_bf16 v[64:67], v[128:131], v[144:147], v[64:67]
    ds_read_b128 v[176:179], v227 offset:0
    v_mfma_f32_16x16x32_bf16 v[68:71], v[128:131], v[148:151], v[68:71]
    ds_read_b64_tr_b16 v[160:161], v234 offset:24576
    v_mfma_f32_16x16x32_bf16 v[72:75], v[128:131], v[152:155], v[72:75]
    ds_read_b64_tr_b16 v[162:163], v234 offset:25600
    buffer_load_dwordx4 v19, s[28:31], s53 offen offset:3072 lds
    v_mfma_f32_16x16x32_bf16 v[76:79], v[128:131], v[156:159], v[76:79]
    ds_read_b128 v[180:183], v227 offset:2048
    s_lshl_b32 s53, s11, 7
    v_mfma_f32_16x16x32_bf16 v[92:95], v[132:135], v[156:159], v[92:95]
    ds_read_b128 v[184:187], v227 offset:4096
    s_add_u32 m0, s52, 0
    v_mfma_f32_16x16x32_bf16 v[88:91], v[132:135], v[152:155], v[88:91]
    ds_read_b128 v[188:191], v227 offset:6144
    s_add_u32 s53, s53, s50
    v_mfma_f32_16x16x32_bf16 v[84:87], v[132:135], v[148:151], v[84:87]
    ds_read_b64_tr_b16 v[164:165], v235 offset:24576
    buffer_load_dwordx4 v12, s[24:27], s53 offen offset:0 lds
    v_mfma_f32_16x16x32_bf16 v[80:83], v[132:135], v[144:147], v[80:83]
    ds_read_b64_tr_b16 v[166:167], v235 offset:25600
    s_waitcnt lgkmcnt(8)
    v_mfma_f32_16x16x32_bf16 v[96:99], v[136:139], v[144:147], v[96:99]
    ds_read_b64_tr_b16 v[168:169], v236 offset:24576
    v_mfma_f32_16x16x32_bf16 v[100:103], v[136:139], v[148:151], v[100:103]
    ds_read_b64_tr_b16 v[170:171], v236 offset:25600
    v_mfma_f32_16x16x32_bf16 v[104:107], v[136:139], v[152:155], v[104:107]
    ds_read_b64_tr_b16 v[172:173], v237 offset:24576
    buffer_load_dwordx4 v13, s[24:27], s53 offen offset:1024 lds
    v_mfma_f32_16x16x32_bf16 v[108:111], v[136:139], v[156:159], v[108:111]
    ds_read_b64_tr_b16 v[174:175], v237 offset:25600
    v_mfma_f32_16x16x32_bf16 v[124:127], v[140:143], v[156:159], v[124:127]
    v_mfma_f32_16x16x32_bf16 v[120:123], v[140:143], v[152:155], v[120:123]
    v_mfma_f32_16x16x32_bf16 v[116:119], v[140:143], v[148:151], v[116:119]
    buffer_load_dwordx4 v14, s[24:27], s53 offen offset:2048 lds
    v_mfma_f32_16x16x32_bf16 v[112:115], v[140:143], v[144:147], v[112:115]
    s_waitcnt vmcnt(11)
    s_barrier
    s_waitcnt lgkmcnt(4)
    v_mfma_f32_16x16x32_bf16 v[64:67], v[160:163], v[176:179], v[64:67]
    ds_read_b128 v[144:147], v226 offset:32768
    v_mfma_f32_16x16x32_bf16 v[68:71], v[160:163], v[180:183], v[68:71]
    ds_read_b64_tr_b16 v[128:129], v234 offset:49152
    v_mfma_f32_16x16x32_bf16 v[72:75], v[160:163], v[184:187], v[72:75]
    ds_read_b64_tr_b16 v[130:131], v234 offset:50176
    buffer_load_dwordx4 v15, s[24:27], s53 offen offset:3072 lds
    v_mfma_f32_16x16x32_bf16 v[76:79], v[160:163], v[188:191], v[76:79]
    ds_read_b128 v[148:151], v226 offset:34816
    s_mul_i32 s53, s11, 229376
    v_mfma_f32_16x16x32_bf16 v[92:95], v[164:167], v[188:191], v[92:95]
    ds_read_b128 v[152:155], v226 offset:36864
    s_add_u32 m0, s52, 16384
    v_mfma_f32_16x16x32_bf16 v[88:91], v[164:167], v[184:187], v[88:91]
    ds_read_b128 v[156:159], v226 offset:38912
    s_add_u32 s53, s53, s51
    v_mfma_f32_16x16x32_bf16 v[84:87], v[164:167], v[180:183], v[84:87]
    ds_read_b64_tr_b16 v[132:133], v235 offset:49152
    buffer_load_dwordx4 v16, s[28:31], s53 offen offset:0 lds
    v_mfma_f32_16x16x32_bf16 v[80:83], v[164:167], v[176:179], v[80:83]
    ds_read_b64_tr_b16 v[134:135], v235 offset:50176
    s_waitcnt lgkmcnt(8)
    v_mfma_f32_16x16x32_bf16 v[96:99], v[168:171], v[176:179], v[96:99]
    ds_read_b64_tr_b16 v[136:137], v236 offset:49152
    v_mfma_f32_16x16x32_bf16 v[100:103], v[168:171], v[180:183], v[100:103]
    ds_read_b64_tr_b16 v[138:139], v236 offset:50176
    v_mfma_f32_16x16x32_bf16 v[104:107], v[168:171], v[184:187], v[104:107]
    ds_read_b64_tr_b16 v[140:141], v237 offset:49152
    buffer_load_dwordx4 v17, s[28:31], s53 offen offset:1024 lds
    v_mfma_f32_16x16x32_bf16 v[108:111], v[168:171], v[188:191], v[108:111]
    ds_read_b64_tr_b16 v[142:143], v237 offset:50176
    v_mfma_f32_16x16x32_bf16 v[124:127], v[172:175], v[188:191], v[124:127]
    v_mfma_f32_16x16x32_bf16 v[120:123], v[172:175], v[184:187], v[120:123]
    v_mfma_f32_16x16x32_bf16 v[116:119], v[172:175], v[180:183], v[116:119]
    buffer_load_dwordx4 v18, s[28:31], s53 offen offset:2048 lds
    v_mfma_f32_16x16x32_bf16 v[112:115], v[172:175], v[176:179], v[112:115]
    s_waitcnt lgkmcnt(4)
    v_mfma_f32_16x16x32_bf16 v[64:67], v[128:131], v[144:147], v[64:67]
    ds_read_b128 v[176:179], v227 offset:32768
    v_mfma_f32_16x16x32_bf16 v[68:71], v[128:131], v[148:151], v[68:71]
    ds_read_b64_tr_b16 v[160:161], v234 offset:57344
    v_mfma_f32_16x16x32_bf16 v[72:75], v[128:131], v[152:155], v[72:75]
    ds_read_b64_tr_b16 v[162:163], v234 offset:58368
    buffer_load_dwordx4 v19, s[28:31], s53 offen offset:3072 lds
    v_mfma_f32_16x16x32_bf16 v[76:79], v[128:131], v[156:159], v[76:79]
    ds_read_b128 v[180:183], v227 offset:34816
    s_lshl_b32 s53, s14, 7
    v_mfma_f32_16x16x32_bf16 v[92:95], v[132:135], v[156:159], v[92:95]
    ds_read_b128 v[184:187], v227 offset:36864
    s_add_u32 m0, s52, 32768
    v_mfma_f32_16x16x32_bf16 v[88:91], v[132:135], v[152:155], v[88:91]
    ds_read_b128 v[188:191], v227 offset:38912
    s_add_u32 s53, s53, s50
    v_mfma_f32_16x16x32_bf16 v[84:87], v[132:135], v[148:151], v[84:87]
    ds_read_b64_tr_b16 v[164:165], v235 offset:57344
    buffer_load_dwordx4 v12, s[24:27], s53 offen offset:0 lds
    v_mfma_f32_16x16x32_bf16 v[80:83], v[132:135], v[144:147], v[80:83]
    ds_read_b64_tr_b16 v[166:167], v235 offset:58368
    s_waitcnt lgkmcnt(8)
    v_mfma_f32_16x16x32_bf16 v[96:99], v[136:139], v[144:147], v[96:99]
    ds_read_b64_tr_b16 v[168:169], v236 offset:57344
    v_mfma_f32_16x16x32_bf16 v[100:103], v[136:139], v[148:151], v[100:103]
    ds_read_b64_tr_b16 v[170:171], v236 offset:58368
    v_mfma_f32_16x16x32_bf16 v[104:107], v[136:139], v[152:155], v[104:107]
    ds_read_b64_tr_b16 v[172:173], v237 offset:57344
    buffer_load_dwordx4 v13, s[24:27], s53 offen offset:1024 lds
    v_mfma_f32_16x16x32_bf16 v[108:111], v[136:139], v[156:159], v[108:111]
    ds_read_b64_tr_b16 v[174:175], v237 offset:58368
    v_mfma_f32_16x16x32_bf16 v[124:127], v[140:143], v[156:159], v[124:127]
    v_mfma_f32_16x16x32_bf16 v[120:123], v[140:143], v[152:155], v[120:123]
    v_mfma_f32_16x16x32_bf16 v[116:119], v[140:143], v[148:151], v[116:119]
    buffer_load_dwordx4 v14, s[24:27], s53 offen offset:2048 lds
    v_mfma_f32_16x16x32_bf16 v[112:115], v[140:143], v[144:147], v[112:115]
    s_waitcnt vmcnt(11)
    s_barrier
    s_waitcnt lgkmcnt(4)
    v_mfma_f32_16x16x32_bf16 v[64:67], v[160:163], v[176:179], v[64:67]
    ds_read_b128 v[144:147], v228 offset:0
    v_mfma_f32_16x16x32_bf16 v[68:71], v[160:163], v[180:183], v[68:71]
    ds_read_b64_tr_b16 v[128:129], v238 offset:16384
    v_mfma_f32_16x16x32_bf16 v[72:75], v[160:163], v[184:187], v[72:75]
    ds_read_b64_tr_b16 v[130:131], v238 offset:17408
    buffer_load_dwordx4 v15, s[24:27], s53 offen offset:3072 lds
    v_mfma_f32_16x16x32_bf16 v[76:79], v[160:163], v[188:191], v[76:79]
    ds_read_b128 v[148:151], v228 offset:2048
    s_mul_i32 s53, s14, 229376
    v_mfma_f32_16x16x32_bf16 v[92:95], v[164:167], v[188:191], v[92:95]
    ds_read_b128 v[152:155], v228 offset:4096
    s_add_u32 m0, s52, 49152
    v_mfma_f32_16x16x32_bf16 v[88:91], v[164:167], v[184:187], v[88:91]
    ds_read_b128 v[156:159], v228 offset:6144
    s_add_u32 s53, s53, s51
    v_mfma_f32_16x16x32_bf16 v[84:87], v[164:167], v[180:183], v[84:87]
    ds_read_b64_tr_b16 v[132:133], v239 offset:16384
    buffer_load_dwordx4 v16, s[28:31], s53 offen offset:0 lds
    v_mfma_f32_16x16x32_bf16 v[80:83], v[164:167], v[176:179], v[80:83]
    ds_read_b64_tr_b16 v[134:135], v239 offset:17408
    s_waitcnt lgkmcnt(8)
    v_mfma_f32_16x16x32_bf16 v[96:99], v[168:171], v[176:179], v[96:99]
    ds_read_b64_tr_b16 v[136:137], v240 offset:16384
    v_mfma_f32_16x16x32_bf16 v[100:103], v[168:171], v[180:183], v[100:103]
    ds_read_b64_tr_b16 v[138:139], v240 offset:17408
    v_mfma_f32_16x16x32_bf16 v[104:107], v[168:171], v[184:187], v[104:107]
    ds_read_b64_tr_b16 v[140:141], v241 offset:16384
    buffer_load_dwordx4 v17, s[28:31], s53 offen offset:1024 lds
    v_mfma_f32_16x16x32_bf16 v[108:111], v[168:171], v[188:191], v[108:111]
    ds_read_b64_tr_b16 v[142:143], v241 offset:17408
    v_mfma_f32_16x16x32_bf16 v[124:127], v[172:175], v[188:191], v[124:127]
    v_mfma_f32_16x16x32_bf16 v[120:123], v[172:175], v[184:187], v[120:123]
    v_mfma_f32_16x16x32_bf16 v[116:119], v[172:175], v[180:183], v[116:119]
    buffer_load_dwordx4 v18, s[28:31], s53 offen offset:2048 lds
    v_mfma_f32_16x16x32_bf16 v[112:115], v[172:175], v[176:179], v[112:115]
    s_waitcnt lgkmcnt(4)
    v_mfma_f32_16x16x32_bf16 v[64:67], v[128:131], v[144:147], v[64:67]
    ds_read_b128 v[176:179], v229 offset:0
    v_mfma_f32_16x16x32_bf16 v[68:71], v[128:131], v[148:151], v[68:71]
    ds_read_b64_tr_b16 v[160:161], v238 offset:24576
    v_mfma_f32_16x16x32_bf16 v[72:75], v[128:131], v[152:155], v[72:75]
    ds_read_b64_tr_b16 v[162:163], v238 offset:25600
    buffer_load_dwordx4 v19, s[28:31], s53 offen offset:3072 lds
    v_mfma_f32_16x16x32_bf16 v[76:79], v[128:131], v[156:159], v[76:79]
    ds_read_b128 v[180:183], v229 offset:2048
    s_lshl_b32 s53, s15, 7
    v_mfma_f32_16x16x32_bf16 v[92:95], v[132:135], v[156:159], v[92:95]
    ds_read_b128 v[184:187], v229 offset:4096
    s_add_u32 m0, s52, 65536
    v_mfma_f32_16x16x32_bf16 v[88:91], v[132:135], v[152:155], v[88:91]
    ds_read_b128 v[188:191], v229 offset:6144
    s_add_u32 s53, s53, s50
    v_mfma_f32_16x16x32_bf16 v[84:87], v[132:135], v[148:151], v[84:87]
    ds_read_b64_tr_b16 v[164:165], v239 offset:24576
    buffer_load_dwordx4 v12, s[24:27], s53 offen offset:0 lds
    v_mfma_f32_16x16x32_bf16 v[80:83], v[132:135], v[144:147], v[80:83]
    ds_read_b64_tr_b16 v[166:167], v239 offset:25600
    s_waitcnt lgkmcnt(8)
    v_mfma_f32_16x16x32_bf16 v[96:99], v[136:139], v[144:147], v[96:99]
    ds_read_b64_tr_b16 v[168:169], v240 offset:24576
    v_mfma_f32_16x16x32_bf16 v[100:103], v[136:139], v[148:151], v[100:103]
    ds_read_b64_tr_b16 v[170:171], v240 offset:25600
    v_mfma_f32_16x16x32_bf16 v[104:107], v[136:139], v[152:155], v[104:107]
    ds_read_b64_tr_b16 v[172:173], v241 offset:24576
    buffer_load_dwordx4 v13, s[24:27], s53 offen offset:1024 lds
    v_mfma_f32_16x16x32_bf16 v[108:111], v[136:139], v[156:159], v[108:111]
    ds_read_b64_tr_b16 v[174:175], v241 offset:25600
    v_mfma_f32_16x16x32_bf16 v[124:127], v[140:143], v[156:159], v[124:127]
    v_mfma_f32_16x16x32_bf16 v[120:123], v[140:143], v[152:155], v[120:123]
    v_mfma_f32_16x16x32_bf16 v[116:119], v[140:143], v[148:151], v[116:119]
    buffer_load_dwordx4 v14, s[24:27], s53 offen offset:2048 lds
    v_mfma_f32_16x16x32_bf16 v[112:115], v[140:143], v[144:147], v[112:115]
    s_waitcnt vmcnt(11)
    s_barrier
    s_waitcnt lgkmcnt(4)
    v_mfma_f32_16x16x32_bf16 v[64:67], v[160:163], v[176:179], v[64:67]
    ds_read_b128 v[144:147], v224 offset:0
    v_mfma_f32_16x16x32_bf16 v[68:71], v[160:163], v[180:183], v[68:71]
    ds_read_b64_tr_b16 v[128:129], v230 offset:16384
    v_mfma_f32_16x16x32_bf16 v[72:75], v[160:163], v[184:187], v[72:75]
    ds_read_b64_tr_b16 v[130:131], v230 offset:17408
    buffer_load_dwordx4 v15, s[24:27], s53 offen offset:3072 lds
    v_mfma_f32_16x16x32_bf16 v[76:79], v[160:163], v[188:191], v[76:79]
    ds_read_b128 v[148:151], v224 offset:2048
    s_mul_i32 s53, s15, 229376
    v_mfma_f32_16x16x32_bf16 v[92:95], v[164:167], v[188:191], v[92:95]
    ds_read_b128 v[152:155], v224 offset:4096
    s_add_u32 m0, s52, 81920
    v_mfma_f32_16x16x32_bf16 v[88:91], v[164:167], v[184:187], v[88:91]
    ds_read_b128 v[156:159], v224 offset:6144
    s_add_u32 s53, s53, s51
    v_mfma_f32_16x16x32_bf16 v[84:87], v[164:167], v[180:183], v[84:87]
    ds_read_b64_tr_b16 v[132:133], v231 offset:16384
    buffer_load_dwordx4 v16, s[28:31], s53 offen offset:0 lds
    v_mfma_f32_16x16x32_bf16 v[80:83], v[164:167], v[176:179], v[80:83]
    ds_read_b64_tr_b16 v[134:135], v231 offset:17408
    s_waitcnt lgkmcnt(8)
    v_mfma_f32_16x16x32_bf16 v[96:99], v[168:171], v[176:179], v[96:99]
    ds_read_b64_tr_b16 v[136:137], v232 offset:16384
    v_mfma_f32_16x16x32_bf16 v[100:103], v[168:171], v[180:183], v[100:103]
    ds_read_b64_tr_b16 v[138:139], v232 offset:17408
    v_mfma_f32_16x16x32_bf16 v[104:107], v[168:171], v[184:187], v[104:107]
    ds_read_b64_tr_b16 v[140:141], v233 offset:16384
    buffer_load_dwordx4 v17, s[28:31], s53 offen offset:1024 lds
    v_mfma_f32_16x16x32_bf16 v[108:111], v[168:171], v[188:191], v[108:111]
    ds_read_b64_tr_b16 v[142:143], v233 offset:17408
    v_mfma_f32_16x16x32_bf16 v[124:127], v[172:175], v[188:191], v[124:127]
    v_mfma_f32_16x16x32_bf16 v[120:123], v[172:175], v[184:187], v[120:123]
    v_mfma_f32_16x16x32_bf16 v[116:119], v[172:175], v[180:183], v[116:119]
    buffer_load_dwordx4 v18, s[28:31], s53 offen offset:2048 lds
    v_mfma_f32_16x16x32_bf16 v[112:115], v[172:175], v[176:179], v[112:115]
    s_waitcnt lgkmcnt(4)
    v_mfma_f32_16x16x32_bf16 v[64:67], v[128:131], v[144:147], v[64:67]
    ds_read_b128 v[176:179], v225 offset:0
    v_mfma_f32_16x16x32_bf16 v[68:71], v[128:131], v[148:151], v[68:71]
    ds_read_b64_tr_b16 v[160:161], v230 offset:24576
    v_mfma_f32_16x16x32_bf16 v[72:75], v[128:131], v[152:155], v[72:75]
    ds_read_b64_tr_b16 v[162:163], v230 offset:25600
    buffer_load_dwordx4 v19, s[28:31], s53 offen offset:3072 lds
    v_mfma_f32_16x16x32_bf16 v[76:79], v[128:131], v[156:159], v[76:79]
    ds_read_b128 v[180:183], v225 offset:2048
    s_lshl_b32 s53, s64, 5
    v_mfma_f32_16x16x32_bf16 v[92:95], v[132:135], v[156:159], v[92:95]
    ds_read_b128 v[184:187], v225 offset:4096
    s_add_u32 m0, s57, 98304
    v_mfma_f32_16x16x32_bf16 v[88:91], v[132:135], v[152:155], v[88:91]
    ds_read_b128 v[188:191], v225 offset:6144
    s_add_u32 s53, s53, s56
    v_mfma_f32_16x16x32_bf16 v[84:87], v[132:135], v[148:151], v[84:87]
    ds_read_b64_tr_b16 v[164:165], v231 offset:24576
    buffer_load_dwordx4 v20, s[32:35], s53 offen offset:0 lds
    v_mfma_f32_16x16x32_bf16 v[80:83], v[132:135], v[144:147], v[80:83]
    ds_read_b64_tr_b16 v[166:167], v231 offset:25600
    s_waitcnt lgkmcnt(8)
    v_mfma_f32_16x16x32_bf16 v[96:99], v[136:139], v[144:147], v[96:99]
    ds_read_b64_tr_b16 v[168:169], v232 offset:24576
    v_mfma_f32_16x16x32_bf16 v[100:103], v[136:139], v[148:151], v[100:103]
    ds_read_b64_tr_b16 v[170:171], v232 offset:25600
    v_mfma_f32_16x16x32_bf16 v[104:107], v[136:139], v[152:155], v[104:107]
    ds_read_b64_tr_b16 v[172:173], v233 offset:24576
    buffer_load_dwordx4 v21, s[32:35], s53 offen offset:1024 lds
    v_mfma_f32_16x16x32_bf16 v[108:111], v[136:139], v[156:159], v[108:111]
    ds_read_b64_tr_b16 v[174:175], v233 offset:25600
    v_mfma_f32_16x16x32_bf16 v[124:127], v[140:143], v[156:159], v[124:127]
    v_mfma_f32_16x16x32_bf16 v[120:123], v[140:143], v[152:155], v[120:123]
    v_mfma_f32_16x16x32_bf16 v[116:119], v[140:143], v[148:151], v[116:119]
    buffer_load_dwordx4 v22, s[32:35], s53 offen offset:2048 lds
    v_mfma_f32_16x16x32_bf16 v[112:115], v[140:143], v[144:147], v[112:115]
    s_waitcnt vmcnt(11)
    s_barrier
    s_waitcnt lgkmcnt(4)
    v_mfma_f32_16x16x32_bf16 v[64:67], v[160:163], v[176:179], v[64:67]
    ds_read_b128 v[144:147], v224 offset:32768
    v_mfma_f32_16x16x32_bf16 v[68:71], v[160:163], v[180:183], v[68:71]
    ds_read_b64_tr_b16 v[128:129], v230 offset:49152
    v_mfma_f32_16x16x32_bf16 v[72:75], v[160:163], v[184:187], v[72:75]
    ds_read_b64_tr_b16 v[130:131], v230 offset:50176
    buffer_load_dwordx4 v23, s[32:35], s53 offen offset:3072 lds
    v_mfma_f32_16x16x32_bf16 v[76:79], v[160:163], v[188:191], v[76:79]
    ds_read_b128 v[148:151], v224 offset:34816
    s_lshl_b32 s53, s65, 5
    v_mfma_f32_16x16x32_bf16 v[92:95], v[164:167], v[188:191], v[92:95]
    ds_read_b128 v[152:155], v224 offset:36864
    s_add_u32 m0, s57, 102400
    v_mfma_f32_16x16x32_bf16 v[88:91], v[164:167], v[184:187], v[88:91]
    ds_read_b128 v[156:159], v224 offset:38912
    s_add_u32 s53, s53, s56
    v_mfma_f32_16x16x32_bf16 v[84:87], v[164:167], v[180:183], v[84:87]
    ds_read_b64_tr_b16 v[132:133], v231 offset:49152
    buffer_load_dwordx4 v20, s[32:35], s53 offen offset:0 lds
    v_mfma_f32_16x16x32_bf16 v[80:83], v[164:167], v[176:179], v[80:83]
    ds_read_b64_tr_b16 v[134:135], v231 offset:50176
    s_waitcnt lgkmcnt(8)
    v_mfma_f32_16x16x32_bf16 v[96:99], v[168:171], v[176:179], v[96:99]
    ds_read_b64_tr_b16 v[136:137], v232 offset:49152
    v_mfma_f32_16x16x32_bf16 v[100:103], v[168:171], v[180:183], v[100:103]
    ds_read_b64_tr_b16 v[138:139], v232 offset:50176
    v_mfma_f32_16x16x32_bf16 v[104:107], v[168:171], v[184:187], v[104:107]
    ds_read_b64_tr_b16 v[140:141], v233 offset:49152
    buffer_load_dwordx4 v21, s[32:35], s53 offen offset:1024 lds
    v_mfma_f32_16x16x32_bf16 v[108:111], v[168:171], v[188:191], v[108:111]
    ds_read_b64_tr_b16 v[142:143], v233 offset:50176
    v_mfma_f32_16x16x32_bf16 v[124:127], v[172:175], v[188:191], v[124:127]
    v_mfma_f32_16x16x32_bf16 v[120:123], v[172:175], v[184:187], v[120:123]
    v_mfma_f32_16x16x32_bf16 v[116:119], v[172:175], v[180:183], v[116:119]
    buffer_load_dwordx4 v22, s[32:35], s53 offen offset:2048 lds
    v_mfma_f32_16x16x32_bf16 v[112:115], v[172:175], v[176:179], v[112:115]
    s_waitcnt lgkmcnt(4)
    v_mfma_f32_16x16x32_bf16 v[64:67], v[128:131], v[144:147], v[64:67]
    ds_read_b128 v[176:179], v225 offset:32768
    v_mfma_f32_16x16x32_bf16 v[68:71], v[128:131], v[148:151], v[68:71]
    ds_read_b64_tr_b16 v[160:161], v230 offset:57344
    v_mfma_f32_16x16x32_bf16 v[72:75], v[128:131], v[152:155], v[72:75]
    ds_read_b64_tr_b16 v[162:163], v230 offset:58368
    buffer_load_dwordx4 v23, s[32:35], s53 offen offset:3072 lds
    v_mfma_f32_16x16x32_bf16 v[76:79], v[128:131], v[156:159], v[76:79]
    ds_read_b128 v[180:183], v225 offset:34816
    s_lshl_b32 s53, s66, 5
    v_mfma_f32_16x16x32_bf16 v[92:95], v[132:135], v[156:159], v[92:95]
    ds_read_b128 v[184:187], v225 offset:36864
    s_add_u32 m0, s57, 131072
    v_mfma_f32_16x16x32_bf16 v[88:91], v[132:135], v[152:155], v[88:91]
    ds_read_b128 v[188:191], v225 offset:38912
    s_add_u32 s53, s53, s56
    v_mfma_f32_16x16x32_bf16 v[84:87], v[132:135], v[148:151], v[84:87]
    ds_read_b64_tr_b16 v[164:165], v231 offset:57344
    buffer_load_dwordx4 v20, s[32:35], s53 offen offset:0 lds
    v_mfma_f32_16x16x32_bf16 v[80:83], v[132:135], v[144:147], v[80:83]
    ds_read_b64_tr_b16 v[166:167], v231 offset:58368
    s_waitcnt lgkmcnt(8)
    v_mfma_f32_16x16x32_bf16 v[96:99], v[136:139], v[144:147], v[96:99]
    ds_read_b64_tr_b16 v[168:169], v232 offset:57344
    v_mfma_f32_16x16x32_bf16 v[100:103], v[136:139], v[148:151], v[100:103]
    ds_read_b64_tr_b16 v[170:171], v232 offset:58368
    v_mfma_f32_16x16x32_bf16 v[104:107], v[136:139], v[152:155], v[104:107]
    ds_read_b64_tr_b16 v[172:173], v233 offset:57344
    buffer_load_dwordx4 v21, s[32:35], s53 offen offset:1024 lds
    v_mfma_f32_16x16x32_bf16 v[108:111], v[136:139], v[156:159], v[108:111]
    ds_read_b64_tr_b16 v[174:175], v233 offset:58368
    v_mfma_f32_16x16x32_bf16 v[124:127], v[140:143], v[156:159], v[124:127]
    v_mfma_f32_16x16x32_bf16 v[120:123], v[140:143], v[152:155], v[120:123]
    v_mfma_f32_16x16x32_bf16 v[116:119], v[140:143], v[148:151], v[116:119]
    buffer_load_dwordx4 v22, s[32:35], s53 offen offset:2048 lds
    v_mfma_f32_16x16x32_bf16 v[112:115], v[140:143], v[144:147], v[112:115]
    s_waitcnt vmcnt(11)
    s_barrier
    s_waitcnt lgkmcnt(4)
    v_mfma_f32_16x16x32_bf16 v[64:67], v[160:163], v[176:179], v[64:67]
    ds_read_b128 v[144:147], v226 offset:0
    v_mfma_f32_16x16x32_bf16 v[68:71], v[160:163], v[180:183], v[68:71]
    ds_read_b64_tr_b16 v[128:129], v234 offset:16384
    v_mfma_f32_16x16x32_bf16 v[72:75], v[160:163], v[184:187], v[72:75]
    ds_read_b64_tr_b16 v[130:131], v234 offset:17408
    buffer_load_dwordx4 v23, s[32:35], s53 offen offset:3072 lds
    v_mfma_f32_16x16x32_bf16 v[76:79], v[160:163], v[188:191], v[76:79]
    ds_read_b128 v[148:151], v226 offset:2048
    s_lshl_b32 s53, s67, 5
    v_mfma_f32_16x16x32_bf16 v[92:95], v[164:167], v[188:191], v[92:95]
    ds_read_b128 v[152:155], v226 offset:4096
    s_add_u32 m0, s57, 135168
    v_mfma_f32_16x16x32_bf16 v[88:91], v[164:167], v[184:187], v[88:91]
    ds_read_b128 v[156:159], v226 offset:6144
    s_add_u32 s53, s53, s56
    v_mfma_f32_16x16x32_bf16 v[84:87], v[164:167], v[180:183], v[84:87]
    ds_read_b64_tr_b16 v[132:133], v235 offset:16384
    buffer_load_dwordx4 v20, s[32:35], s53 offen offset:0 lds
    v_mfma_f32_16x16x32_bf16 v[80:83], v[164:167], v[176:179], v[80:83]
    ds_read_b64_tr_b16 v[134:135], v235 offset:17408
    s_waitcnt lgkmcnt(8)
    v_mfma_f32_16x16x32_bf16 v[96:99], v[168:171], v[176:179], v[96:99]
    ds_read_b64_tr_b16 v[136:137], v236 offset:16384
    v_mfma_f32_16x16x32_bf16 v[100:103], v[168:171], v[180:183], v[100:103]
    ds_read_b64_tr_b16 v[138:139], v236 offset:17408
    v_mfma_f32_16x16x32_bf16 v[104:107], v[168:171], v[184:187], v[104:107]
    ds_read_b64_tr_b16 v[140:141], v237 offset:16384
    buffer_load_dwordx4 v21, s[32:35], s53 offen offset:1024 lds
    v_mfma_f32_16x16x32_bf16 v[108:111], v[168:171], v[188:191], v[108:111]
    ds_read_b64_tr_b16 v[142:143], v237 offset:17408
    v_mfma_f32_16x16x32_bf16 v[124:127], v[172:175], v[188:191], v[124:127]
    v_mfma_f32_16x16x32_bf16 v[120:123], v[172:175], v[184:187], v[120:123]
    v_mfma_f32_16x16x32_bf16 v[116:119], v[172:175], v[180:183], v[116:119]
    buffer_load_dwordx4 v22, s[32:35], s53 offen offset:2048 lds
    v_mfma_f32_16x16x32_bf16 v[112:115], v[172:175], v[176:179], v[112:115]
    s_waitcnt lgkmcnt(4)
    v_mfma_f32_16x16x32_bf16 v[64:67], v[128:131], v[144:147], v[64:67]
    ds_read_b128 v[176:179], v227 offset:0
    ds_read_b64_tr_b16 v[160:161], v234 offset:24576
    v_mfma_f32_16x16x32_bf16 v[68:71], v[128:131], v[148:151], v[68:71]
    ds_read_b64_tr_b16 v[162:163], v234 offset:25600
    ds_read_b128 v[180:183], v227 offset:2048
    v_mfma_f32_16x16x32_bf16 v[72:75], v[128:131], v[152:155], v[72:75]
    ds_read_b128 v[184:187], v227 offset:4096
    ds_read_b128 v[188:191], v227 offset:6144
    v_mfma_f32_16x16x32_bf16 v[76:79], v[128:131], v[156:159], v[76:79]
    ds_read_b64_tr_b16 v[164:165], v235 offset:24576
    ds_read_b64_tr_b16 v[166:167], v235 offset:25600
    v_mfma_f32_16x16x32_bf16 v[92:95], v[132:135], v[156:159], v[92:95]
    ds_read_b64_tr_b16 v[168:169], v236 offset:24576
    v_mfma_f32_16x16x32_bf16 v[88:91], v[132:135], v[152:155], v[88:91]
    ds_read_b64_tr_b16 v[170:171], v236 offset:25600
    v_mfma_f32_16x16x32_bf16 v[84:87], v[132:135], v[148:151], v[84:87]
    ds_read_b64_tr_b16 v[172:173], v237 offset:24576
    v_mfma_f32_16x16x32_bf16 v[80:83], v[132:135], v[144:147], v[80:83]
    ds_read_b64_tr_b16 v[174:175], v237 offset:25600
    s_waitcnt lgkmcnt(4)
    v_mfma_f32_16x16x32_bf16 v[64:67], v[160:163], v[176:179], v[64:67]
    buffer_load_dwordx4 v23, s[32:35], s53 offen offset:3072 lds
    s_lshl_b32 s53, s68, 5
    s_add_u32 m0, s57, 0
    s_add_u32 s53, s53, s56
    buffer_load_dwordx4 v20, s[32:35], s53 offen offset:0 lds
    v_mfma_f32_16x16x32_bf16 v[68:71], v[160:163], v[180:183], v[68:71]
    v_mfma_f32_16x16x32_bf16 v[72:75], v[160:163], v[184:187], v[72:75]
    buffer_load_dwordx4 v21, s[32:35], s53 offen offset:1024 lds
    v_mfma_f32_16x16x32_bf16 v[76:79], v[160:163], v[188:191], v[76:79]
    v_mfma_f32_16x16x32_bf16 v[92:95], v[164:167], v[188:191], v[92:95]
    v_mfma_f32_16x16x32_bf16 v[88:91], v[164:167], v[184:187], v[88:91]
    v_mfma_f32_16x16x32_bf16 v[84:87], v[164:167], v[180:183], v[84:87]
    buffer_load_dwordx4 v22, s[32:35], s53 offen offset:2048 lds
    v_mfma_f32_16x16x32_bf16 v[80:83], v[164:167], v[176:179], v[80:83]
    buffer_load_dwordx4 v23, s[32:35], s53 offen offset:3072 lds
    v_mfma_f32_16x16x32_bf16 v[96:99], v[136:139], v[144:147], v[96:99]
    s_nop 2
    v_mfma_f32_16x16x32_bf16 v[100:103], v[136:139], v[148:151], v[100:103]
    v_max_f32 v64, 0, v64
    v_max_f32 v65, 0, v65
    v_mfma_f32_16x16x32_bf16 v[104:107], v[136:139], v[152:155], v[104:107]
    v_max_f32 v66, 0, v66
    v_max_f32 v67, 0, v67
    v_mfma_f32_16x16x32_bf16 v[108:111], v[136:139], v[156:159], v[108:111]
    v_pk_mul_f32 v[64:65], v[64:65], v[64:65]
    v_pk_mul_f32 v[66:67], v[66:67], v[66:67]
    v_mfma_f32_16x16x32_bf16 v[124:127], v[140:143], v[156:159], v[124:127]
    v_cvt_pk_bf16_f32 v192, v64, v65
    v_cvt_pk_bf16_f32 v193, v66, v67
    v_mfma_f32_16x16x32_bf16 v[120:123], v[140:143], v[152:155], v[120:123]
    v_max_f32 v80, 0, v80
    v_max_f32 v81, 0, v81
    v_mfma_f32_16x16x32_bf16 v[116:119], v[140:143], v[148:151], v[116:119]
    v_max_f32 v82, 0, v82
    v_max_f32 v83, 0, v83
    v_mfma_f32_16x16x32_bf16 v[112:115], v[140:143], v[144:147], v[112:115]
    v_pk_mul_f32 v[80:81], v[80:81], v[80:81]
    v_pk_mul_f32 v[82:83], v[82:83], v[82:83]
    s_waitcnt lgkmcnt(0)
    v_mfma_f32_16x16x32_bf16 v[96:99], v[168:171], v[176:179], v[96:99]
    v_cvt_pk_bf16_f32 v194, v80, v81
    v_cvt_pk_bf16_f32 v195, v82, v83
    v_mfma_f32_16x16x32_bf16 v[100:103], v[168:171], v[180:183], v[100:103]
    buffer_store_dwordx4 v[192:195], v11, s[36:39], s54 offen offset:0 sc1
    v_max_f32 v68, 0, v68
    v_mfma_f32_16x16x32_bf16 v[104:107], v[168:171], v[184:187], v[104:107]
    v_max_f32 v69, 0, v69
    v_max_f32 v70, 0, v70
    v_mfma_f32_16x16x32_bf16 v[108:111], v[168:171], v[188:191], v[108:111]
    v_max_f32 v71, 0, v71
    v_pk_mul_f32 v[68:69], v[68:69], v[68:69]
    v_mfma_f32_16x16x32_bf16 v[124:127], v[172:175], v[188:191], v[124:127]
    s_barrier
    v_pk_mul_f32 v[70:71], v[70:71], v[70:71]
    v_cvt_pk_bf16_f32 v196, v68, v69
    v_mfma_f32_16x16x32_bf16 v[120:123], v[172:175], v[184:187], v[120:123]
    v_cvt_pk_bf16_f32 v197, v70, v71
    v_max_f32 v84, 0, v84
    v_mfma_f32_16x16x32_bf16 v[116:119], v[172:175], v[180:183], v[116:119]
    v_max_f32 v85, 0, v85
    v_max_f32 v86, 0, v86
    v_mfma_f32_16x16x32_bf16 v[112:115], v[172:175], v[176:179], v[112:115]
    v_max_f32 v87, 0, v87
    v_pk_mul_f32 v[84:85], v[84:85], v[84:85]
    v_pk_mul_f32 v[86:87], v[86:87], v[86:87]
    v_cvt_pk_bf16_f32 v198, v84, v85
    v_cvt_pk_bf16_f32 v199, v86, v87
    buffer_store_dwordx4 v[196:199], v27, s[36:39], s54 offen offset:0 sc1
    v_max_f32 v72, 0, v72
    v_max_f32 v73, 0, v73
    v_max_f32 v74, 0, v74
    v_max_f32 v75, 0, v75
    v_pk_mul_f32 v[72:73], v[72:73], v[72:73]
    v_pk_mul_f32 v[74:75], v[74:75], v[74:75]
    v_cvt_pk_bf16_f32 v200, v72, v73
    v_cvt_pk_bf16_f32 v201, v74, v75
    v_max_f32 v88, 0, v88
    v_max_f32 v89, 0, v89
    v_max_f32 v90, 0, v90
    v_max_f32 v91, 0, v91
    v_pk_mul_f32 v[88:89], v[88:89], v[88:89]
    v_pk_mul_f32 v[90:91], v[90:91], v[90:91]
    v_cvt_pk_bf16_f32 v202, v88, v89
    v_cvt_pk_bf16_f32 v203, v90, v91
    buffer_store_dwordx4 v[200:203], v28, s[36:39], s54 offen offset:0 sc1
    v_max_f32 v76, 0, v76
    v_max_f32 v77, 0, v77
    v_max_f32 v78, 0, v78
    v_max_f32 v79, 0, v79
    v_pk_mul_f32 v[76:77], v[76:77], v[76:77]
    v_pk_mul_f32 v[78:79], v[78:79], v[78:79]
    v_cvt_pk_bf16_f32 v204, v76, v77
    v_cvt_pk_bf16_f32 v205, v78, v79
    v_max_f32 v92, 0, v92
    v_max_f32 v93, 0, v93
    v_max_f32 v94, 0, v94
    v_max_f32 v95, 0, v95
    v_pk_mul_f32 v[92:93], v[92:93], v[92:93]
    v_pk_mul_f32 v[94:95], v[94:95], v[94:95]
    v_cvt_pk_bf16_f32 v206, v92, v93
    v_cvt_pk_bf16_f32 v207, v94, v95
    buffer_store_dwordx4 v[204:207], v29, s[36:39], s54 offen offset:0 sc1
    v_max_f32 v96, 0, v96
    v_max_f32 v97, 0, v97
    v_max_f32 v98, 0, v98
    v_max_f32 v99, 0, v99
    v_pk_mul_f32 v[96:97], v[96:97], v[96:97]
    v_pk_mul_f32 v[98:99], v[98:99], v[98:99]
    v_cvt_pk_bf16_f32 v208, v96, v97
    v_cvt_pk_bf16_f32 v209, v98, v99
    v_max_f32 v112, 0, v112
    v_max_f32 v113, 0, v113
    v_max_f32 v114, 0, v114
    v_max_f32 v115, 0, v115
    v_pk_mul_f32 v[112:113], v[112:113], v[112:113]
    v_pk_mul_f32 v[114:115], v[114:115], v[114:115]
    v_cvt_pk_bf16_f32 v210, v112, v113
    v_cvt_pk_bf16_f32 v211, v114, v115
    buffer_store_dwordx4 v[208:211], v11, s[36:39], s54 offen offset:1024 sc1
    v_max_f32 v100, 0, v100
    v_max_f32 v101, 0, v101
    v_max_f32 v102, 0, v102
    v_max_f32 v103, 0, v103
    v_pk_mul_f32 v[100:101], v[100:101], v[100:101]
    v_pk_mul_f32 v[102:103], v[102:103], v[102:103]
    v_cvt_pk_bf16_f32 v212, v100, v101
    v_cvt_pk_bf16_f32 v213, v102, v103
    v_max_f32 v116, 0, v116
    v_max_f32 v117, 0, v117
    v_max_f32 v118, 0, v118
    v_max_f32 v119, 0, v119
    v_pk_mul_f32 v[116:117], v[116:117], v[116:117]
    v_pk_mul_f32 v[118:119], v[118:119], v[118:119]
    v_cvt_pk_bf16_f32 v214, v116, v117
    v_cvt_pk_bf16_f32 v215, v118, v119
    buffer_store_dwordx4 v[212:215], v27, s[36:39], s54 offen offset:1024 sc1
    v_max_f32 v104, 0, v104
    v_max_f32 v105, 0, v105
    v_max_f32 v106, 0, v106
    v_max_f32 v107, 0, v107
    v_pk_mul_f32 v[104:105], v[104:105], v[104:105]
    v_pk_mul_f32 v[106:107], v[106:107], v[106:107]
    v_cvt_pk_bf16_f32 v216, v104, v105
    v_cvt_pk_bf16_f32 v217, v106, v107
    v_max_f32 v120, 0, v120
    v_max_f32 v121, 0, v121
    v_max_f32 v122, 0, v122
    v_max_f32 v123, 0, v123
    v_pk_mul_f32 v[120:121], v[120:121], v[120:121]
    v_pk_mul_f32 v[122:123], v[122:123], v[122:123]
    v_cvt_pk_bf16_f32 v218, v120, v121
    v_cvt_pk_bf16_f32 v219, v122, v123
    buffer_store_dwordx4 v[216:219], v28, s[36:39], s54 offen offset:1024 sc1
    v_max_f32 v108, 0, v108
    v_max_f32 v109, 0, v109
    v_max_f32 v110, 0, v110
    v_max_f32 v111, 0, v111
    v_pk_mul_f32 v[108:109], v[108:109], v[108:109]
    v_pk_mul_f32 v[110:111], v[110:111], v[110:111]
    v_cvt_pk_bf16_f32 v220, v108, v109
    v_cvt_pk_bf16_f32 v221, v110, v111
    v_max_f32 v124, 0, v124
    v_max_f32 v125, 0, v125
    v_max_f32 v126, 0, v126
    v_max_f32 v127, 0, v127
    v_pk_mul_f32 v[124:125], v[124:125], v[124:125]
    v_pk_mul_f32 v[126:127], v[126:127], v[126:127]
    v_cvt_pk_bf16_f32 v222, v124, v125
    v_cvt_pk_bf16_f32 v223, v126, v127
    buffer_store_dwordx4 v[220:223], v29, s[36:39], s54 offen offset:1024 sc1
    global_load_dword v30, v31, s[16:17] sc1
    s_and_b32 s61, s63, 1
    s_mul_i32 s61, s61, 3072
    s_add_u32 s70, s61, 6144
    s_add_u32 s71, s70, 1024
    s_cmp_eq_u32 s71, 12288
    s_cselect_b32 s71, 6144, s71
    s_add_u32 s72, s71, 1024
    s_cmp_eq_u32 s72, 12288
    s_cselect_b32 s72, 6144, s72
    s_add_u32 s73, s72, 1024
    s_cmp_eq_u32 s73, 12288
    s_cselect_b32 s73, 6144, s73
    s_add_u32 s74, s73, 1024
    s_cmp_eq_u32 s74, 12288
    s_cselect_b32 s74, 6144, s74
    s_add_u32 s75, s74, 1024
    s_cmp_eq_u32 s75, 12288
    s_cselect_b32 s75, 6144, s75
    s_and_b32 s61, s63, 1
    s_mul_i32 s61, s61, 1024
    s_add_u32 s76, s61, 12288
    s_add_u32 s77, s76, 1024
    s_cmp_eq_u32 s77, 14336
    s_cselect_b32 s77, 12288, s77
    s_add_u32 s70, s70, s62
    s_sub_u32 s23, s70, 14336
    s_cselect_b32 s70, s70, s23
    s_add_u32 s71, s71, s62
    s_sub_u32 s23, s71, 14336
    s_cselect_b32 s71, s71, s23
    s_add_u32 s72, s72, s62
    s_sub_u32 s23, s72, 14336
    s_cselect_b32 s72, s72, s23
    s_add_u32 s73, s73, s62
    s_sub_u32 s23, s73, 14336
    s_cselect_b32 s73, s73, s23
    s_add_u32 s74, s74, s62
    s_sub_u32 s23, s74, 14336
    s_cselect_b32 s74, s74, s23
    s_add_u32 s75, s75, s62
    s_sub_u32 s23, s75, 14336
    s_cselect_b32 s75, s75, s23
    s_add_u32 s76, s76, s62
    s_sub_u32 s23, s76, 14336
    s_cselect_b32 s76, s76, s23
    s_add_u32 s77, s77, s62
    s_sub_u32 s23, s77, 14336
    s_cselect_b32 s77, s77, s23
    v_lshrrev_b32 v3, 4, v1
    v_bfe_u32 v2, v1, 2, 2
    v_and_b32 v4, 3, v1
    v_lshl_add_u32 v7, v3, 2, v2
    v_bfe_u32 v5, v7, 1, 2
    v_lshlrev_b32 v7, 7, v7
    v_lshl_add_u32 v7, v4, 3, v7
    v_add_u32 v7, s57, v7
    v_lshl_add_u32 v244, v5, 5, v7
    v_xor_b32 v245, 32, v244
    v_xor_b32 v246, 64, v244
    v_xor_b32 v247, 96, v244
    v_add_u32 v248, 65536, v244
    v_add_u32 v249, 65536, v245
    v_add_u32 v250, 65536, v246
    v_add_u32 v251, 65536, v247
    v_add_u32 v252, 131072, v244
    v_add_u32 v253, 131072, v245
    v_add_u32 v254, 131072, v246
    v_add_u32 v255, 131072, v247
    s_lshl_b32 s49, s46, 2
    s_add_u32 s49, s49, s20
    s_lshl_b32 s49, s49, 7
    s_add_u32 s49, s49, 7340032
    v_and_b32 v8, 15, v1
    v_lshrrev_b32 v9, 4, v1
    v_and_b32 v10, 7, v1
    v_xor_b32 v9, v9, v10
    v_lshlrev_b32 v9, 4, v9
    v_lshl_add_u32 v9, v8, 8, v9
    v_add_u32 v2, s57, v9
    v_xor_b32 v3, 64, v2
    v_lshrrev_b32 v8, 4, v0
    v_and_b32 v9, 15, v0
    v_and_b32 v10, 7, v8
    v_xor_b32 v10, v10, v9
    v_lshlrev_b32 v10, 4, v10
    v_lshl_add_u32 v6, v8, 8, v10
    s_lshl_b32 s23, s46, 16
    s_lshl_b32 s55, s47, 7
    s_add_u32 s58, s23, s55
    v_lshlrev_b32 v7, 10, v8
    v_lshl_add_u32 v7, v9, 3, v7
    v_lshlrev_b32 v12, 16, v60
    v_and_b32 v13, 0xffff0000, v60
    v_lshlrev_b32 v14, 16, v61
    v_and_b32 v15, 0xffff0000, v61
    s_mul_i32 s59, s46, 229376
    s_mul_i32 s23, s20, 14336
    s_add_u32 s59, s59, s23
    s_waitcnt vmcnt(25)
    ds_read_b64_tr_b16 a[0:1], v248 offset:32768
    ds_read_b64_tr_b16 a[2:3], v248 offset:34816
    ds_read_b64_tr_b16 a[4:5], v249 offset:32768
    ds_read_b64_tr_b16 a[6:7], v249 offset:34816
    ds_read_b64_tr_b16 a[8:9], v250 offset:32768
    ds_read_b64_tr_b16 a[10:11], v250 offset:34816
    ds_read_b64_tr_b16 a[12:13], v251 offset:32768
    ds_read_b64_tr_b16 a[14:15], v251 offset:34816
    s_waitcnt vmcnt(21)
    ds_read_b64_tr_b16 a[16:17], v248 offset:36864
    ds_read_b64_tr_b16 a[18:19], v248 offset:38912
    ds_read_b64_tr_b16 a[20:21], v249 offset:36864
    ds_read_b64_tr_b16 a[22:23], v249 offset:38912
    ds_read_b64_tr_b16 a[24:25], v250 offset:36864
    ds_read_b64_tr_b16 a[26:27], v250 offset:38912
    ds_read_b64_tr_b16 a[28:29], v251 offset:36864
    ds_read_b64_tr_b16 a[30:31], v251 offset:38912
    s_waitcnt vmcnt(17)
    ds_read_b64_tr_b16 a[32:33], v252 offset:0
    ds_read_b64_tr_b16 a[34:35], v252 offset:2048
    ds_read_b64_tr_b16 a[36:37], v253 offset:0
    ds_read_b64_tr_b16 a[38:39], v253 offset:2048
    ds_read_b64_tr_b16 a[40:41], v254 offset:0
    ds_read_b64_tr_b16 a[42:43], v254 offset:2048
    ds_read_b64_tr_b16 a[44:45], v255 offset:0
    ds_read_b64_tr_b16 a[46:47], v255 offset:2048
    s_waitcnt vmcnt(13)
    ds_read_b64_tr_b16 a[48:49], v252 offset:4096
    ds_read_b64_tr_b16 a[50:51], v252 offset:6144
    ds_read_b64_tr_b16 a[52:53], v253 offset:4096
    ds_read_b64_tr_b16 a[54:55], v253 offset:6144
    ds_read_b64_tr_b16 a[56:57], v254 offset:4096
    ds_read_b64_tr_b16 a[58:59], v254 offset:6144
    ds_read_b64_tr_b16 a[60:61], v255 offset:4096
    ds_read_b64_tr_b16 a[62:63], v255 offset:6144
    s_waitcnt vmcnt(9)
    ds_read_b64_tr_b16 a[64:65], v244 offset:0
    ds_read_b64_tr_b16 a[66:67], v244 offset:2048
    ds_read_b64_tr_b16 a[68:69], v245 offset:0
    ds_read_b64_tr_b16 a[70:71], v245 offset:2048
    ds_read_b64_tr_b16 a[72:73], v246 offset:0
    ds_read_b64_tr_b16 a[74:75], v246 offset:2048
    ds_read_b64_tr_b16 a[76:77], v247 offset:0
    ds_read_b64_tr_b16 a[78:79], v247 offset:2048
    s_waitcnt vmcnt(0)
    s_mov_b32 s23, 262144
L_taga_chk:
    v_readfirstlane_b32 s48, v30
    s_nop 0
    s_cmp_lg_u32 s48, 0
    s_cbranch_scc1 L_taga_ok
    s_sub_u32 s23, s23, 1
    s_cmp_eq_u32 s23, 0
    s_cbranch_scc1 L_taga_ok
    s_sleep 2
    global_load_dword v30, v31, s[16:17] sc1
    s_waitcnt vmcnt(0)
    s_branch L_taga_chk
L_taga_ok:
    s_atomic_swap s48, s[18:19], s44
    s_nop 0
    s_lshl_b32 s53, s69, 5
    s_add_u32 m0, s57, 4096
    s_add_u32 s53, s53, s56
    buffer_load_dwordx4 v20, s[32:35], s53 offen offset:0 lds
    buffer_load_dwordx4 v21, s[32:35], s53 offen offset:1024 lds
    buffer_load_dwordx4 v22, s[32:35], s53 offen offset:2048 lds
    buffer_load_dwordx4 v23, s[32:35], s53 offen offset:3072 lds
    s_lshl_b32 s53, s70, 5
    s_add_u32 m0, s57, 32768
    s_add_u32 s53, s53, s56
    buffer_load_dwordx4 v20, s[32:35], s53 offen offset:0 lds
    buffer_load_dwordx4 v21, s[32:35], s53 offen offset:1024 lds
    buffer_load_dwordx4 v22, s[32:35], s53 offen offset:2048 lds
    buffer_load_dwordx4 v23, s[32:35], s53 offen offset:3072 lds
    s_lshl_b32 s53, s71, 5
    s_add_u32 m0, s57, 36864
    s_add_u32 s53, s53, s56
    buffer_load_dwordx4 v20, s[32:35], s53 offen offset:0 lds
    buffer_load_dwordx4 v21, s[32:35], s53 offen offset:1024 lds
    buffer_load_dwordx4 v22, s[32:35], s53 offen offset:2048 lds
    buffer_load_dwordx4 v23, s[32:35], s53 offen offset:3072 lds
    s_lshl_b32 s53, s72, 5
    s_add_u32 m0, s57, 65536
    s_add_u32 s53, s53, s56
    buffer_load_dwordx4 v20, s[32:35], s53 offen offset:0 lds
    buffer_load_dwordx4 v21, s[32:35], s53 offen offset:1024 lds
    buffer_load_dwordx4 v22, s[32:35], s53 offen offset:2048 lds
    buffer_load_dwordx4 v23, s[32:35], s53 offen offset:3072 lds
    s_waitcnt vmcnt(12)
    ds_read_b64_tr_b16 a[80:81], v244 offset:4096
    ds_read_b64_tr_b16 a[82:83], v244 offset:6144
    ds_read_b64_tr_b16 a[84:85], v245 offset:4096
    ds_read_b64_tr_b16 a[86:87], v245 offset:6144
    ds_read_b64_tr_b16 a[88:89], v246 offset:4096
    ds_read_b64_tr_b16 a[90:91], v246 offset:6144
    ds_read_b64_tr_b16 a[92:93], v247 offset:4096
    ds_read_b64_tr_b16 a[94:95], v247 offset:6144
    s_lshl_b32 s53, s73, 5
    s_add_u32 m0, s57, 69632
    s_add_u32 s53, s53, s56
    buffer_load_dwordx4 v20, s[32:35], s53 offen offset:0 lds
    buffer_load_dwordx4 v21, s[32:35], s53 offen offset:1024 lds
    buffer_load_dwordx4 v22, s[32:35], s53 offen offset:2048 lds
    buffer_load_dwordx4 v23, s[32:35], s53 offen offset:3072 lds
    s_waitcnt vmcnt(12)
    ds_read_b64_tr_b16 a[96:97], v244 offset:32768
    ds_read_b64_tr_b16 a[98:99], v244 offset:34816
    ds_read_b64_tr_b16 a[100:101], v245 offset:32768
    ds_read_b64_tr_b16 a[102:103], v245 offset:34816
    ds_read_b64_tr_b16 a[104:105], v246 offset:32768
    ds_read_b64_tr_b16 a[106:107], v246 offset:34816
    ds_read_b64_tr_b16 a[108:109], v247 offset:32768
    ds_read_b64_tr_b16 a[110:111], v247 offset:34816
    s_waitcnt lgkmcnt(0)
    s_lshl_b32 s53, s74, 5
    s_add_u32 m0, s57, 98304
    s_add_u32 s53, s53, s56
    buffer_load_dwordx4 v20, s[32:35], s53 offen offset:0 lds
    buffer_load_dwordx4 v21, s[32:35], s53 offen offset:1024 lds
    buffer_load_dwordx4 v22, s[32:35], s53 offen offset:2048 lds
    buffer_load_dwordx4 v23, s[32:35], s53 offen offset:3072 lds
    s_waitcnt vmcnt(12)
    ds_read_b64_tr_b16 a[112:113], v244 offset:36864
    ds_read_b64_tr_b16 a[114:115], v244 offset:38912
    ds_read_b64_tr_b16 a[116:117], v245 offset:36864
    ds_read_b64_tr_b16 a[118:119], v245 offset:38912
    ds_read_b64_tr_b16 a[120:121], v246 offset:36864
    ds_read_b64_tr_b16 a[122:123], v246 offset:38912
    ds_read_b64_tr_b16 a[124:125], v247 offset:36864
    ds_read_b64_tr_b16 a[126:127], v247 offset:38912
    s_load_dwordx8 s[4:11], s[18:19], s49 glc
    s_lshl_b32 s53, s75, 5
    s_add_u32 m0, s57, 102400
    s_add_u32 s53, s53, s56
    buffer_load_dwordx4 v20, s[32:35], s53 offen offset:0 lds
    buffer_load_dwordx4 v21, s[32:35], s53 offen offset:1024 lds
    buffer_load_dwordx4 v22, s[32:35], s53 offen offset:2048 lds
    buffer_load_dwordx4 v23, s[32:35], s53 offen offset:3072 lds
    s_waitcnt vmcnt(12)
    ds_read_b64_tr_b16 a[128:129], v248 offset:0
    ds_read_b64_tr_b16 a[130:131], v248 offset:2048
    ds_read_b64_tr_b16 a[132:133], v249 offset:0
    ds_read_b64_tr_b16 a[134:135], v249 offset:2048
    ds_read_b64_tr_b16 a[136:137], v250 offset:0
    ds_read_b64_tr_b16 a[138:139], v250 offset:2048
    ds_read_b64_tr_b16 a[140:141], v251 offset:0
    ds_read_b64_tr_b16 a[142:143], v251 offset:2048
    s_lshl_b32 s53, s76, 5
    s_add_u32 m0, s57, 131072
    s_add_u32 s53, s53, s56
    buffer_load_dwordx4 v20, s[32:35], s53 offen offset:0 lds
    buffer_load_dwordx4 v21, s[32:35], s53 offen offset:1024 lds
    buffer_load_dwordx4 v22, s[32:35], s53 offen offset:2048 lds
    buffer_load_dwordx4 v23, s[32:35], s53 offen offset:3072 lds
    s_waitcnt vmcnt(12)
    ds_read_b64_tr_b16 a[144:145], v248 offset:4096
    ds_read_b64_tr_b16 a[146:147], v248 offset:6144
    ds_read_b64_tr_b16 a[148:149], v249 offset:4096
    ds_read_b64_tr_b16 a[150:151], v249 offset:6144
    ds_read_b64_tr_b16 a[152:153], v250 offset:4096
    ds_read_b64_tr_b16 a[154:155], v250 offset:6144
    ds_read_b64_tr_b16 a[156:157], v251 offset:4096
    ds_read_b64_tr_b16 a[158:159], v251 offset:6144
    s_lshl_b32 s53, s77, 5
    s_add_u32 m0, s57, 135168
    s_add_u32 s53, s53, s56
    buffer_load_dwordx4 v20, s[32:35], s53 offen offset:0 lds
    buffer_load_dwordx4 v21, s[32:35], s53 offen offset:1024 lds
    buffer_load_dwordx4 v22, s[32:35], s53 offen offset:2048 lds
    buffer_load_dwordx4 v23, s[32:35], s53 offen offset:3072 lds
    s_waitcnt vmcnt(12)
    ds_read_b64_tr_b16 a[160:161], v248 offset:32768
    ds_read_b64_tr_b16 a[162:163], v248 offset:34816
    ds_read_b64_tr_b16 a[164:165], v249 offset:32768
    ds_read_b64_tr_b16 a[166:167], v249 offset:34816
    ds_read_b64_tr_b16 a[168:169], v250 offset:32768
    ds_read_b64_tr_b16 a[170:171], v250 offset:34816
    ds_read_b64_tr_b16 a[172:173], v251 offset:32768
    ds_read_b64_tr_b16 a[174:175], v251 offset:34816
    s_branch L_join
L_idle2:
    s_and_b32 s46, s21, 3
    s_lshl_b32 s46, s46, 3
    s_lshr_b32 s23, s21, 2
    s_lshl_b32 s23, s23, 2
    s_add_u32 s46, s46, s23
    s_sub_u32 s23, s22, 28
    s_mov_b32 s47, 3
    s_add_u32 s46, s46, s23
    s_add_u32 s63, s23, s47
    s_mul_i32 s62, s21, 7
    s_lshr_b32 s62, s62, 2
    s_lshl_b32 s62, s62, 10
    v_lshrrev_b32 v2, 3, v1
    v_lshrrev_b32 v3, 4, v1
    v_and_b32 v4, 7, v1
    v_lshlrev_b32 v5, 1, v3
    v_xor_b32 v4, v4, v5
    v_lshlrev_b32 v4, 4, v4
    v_lshl_add_u32 v20, v2, 10, v4
    v_add_u32 v21, 7168, v20
    v_add_u32 v22, 14336, v20
    v_add_u32 v23, 21504, v20
    s_mul_i32 s56, s20, 458752
    s_lshl_b32 s23, s47, 7
    s_add_u32 s56, s56, s23
    s_lshl_b32 s57, s20, 13
    v_mov_b32 v31, 0
    v_add_u32 v27, 57344, v11
    v_add_u32 v28, 114688, v11
    v_add_u32 v29, 172032, v11
    s_and_b32 s23, s63, 3
    s_mul_i32 s23, s23, 7
    s_add_u32 s23, s23, 1
    s_lshr_b32 s23, s23, 1
    s_lshl_b32 s64, s23, 10
    s_add_u32 s65, s64, 1024
    s_cmp_eq_u32 s65, 14336
    s_cselect_b32 s65, 0, s65
    s_add_u32 s66, s65, 1024
    s_cmp_eq_u32 s66, 14336
    s_cselect_b32 s66, 0, s66
    s_add_u32 s67, s66, 1024
    s_cmp_eq_u32 s67, 14336
    s_cselect_b32 s67, 0, s67
    s_add_u32 s68, s67, 1024
    s_cmp_eq_u32 s68, 14336
    s_cselect_b32 s68, 0, s68
    s_add_u32 s69, s68, 1024
    s_cmp_eq_u32 s69, 14336
    s_cselect_b32 s69, 0, s69
    s_add_u32 s70, s69, 1024
    s_cmp_eq_u32 s70, 14336
    s_cselect_b32 s70, 0, s70
    s_add_u32 s71, s70, 1024
    s_cmp_eq_u32 s71, 14336
    s_cselect_b32 s71, 0, s71
    s_add_u32 s72, s71, 1024
    s_cmp_eq_u32 s72, 14336
    s_cselect_b32 s72, 0, s72
    s_add_u32 s73, s72, 1024
    s_cmp_eq_u32 s73, 14336
    s_cselect_b32 s73, 0, s73
    s_add_u32 s74, s73, 1024
    s_cmp_eq_u32 s74, 14336
    s_cselect_b32 s74, 0, s74
    s_add_u32 s75, s74, 1024
    s_cmp_eq_u32 s75, 14336
    s_cselect_b32 s75, 0, s75
    s_add_u32 s76, s75, 1024
    s_cmp_eq_u32 s76, 14336
    s_cselect_b32 s76, 0, s76
    s_add_u32 s77, s76, 1024
    s_cmp_eq_u32 s77, 14336
    s_cselect_b32 s77, 0, s77
    s_add_u32 s64, s64, s62
    s_sub_u32 s23, s64, 14336
    s_cselect_b32 s64, s64, s23
    s_add_u32 s65, s65, s62
    s_sub_u32 s23, s65, 14336
    s_cselect_b32 s65, s65, s23
    s_add_u32 s66, s66, s62
    s_sub_u32 s23, s66, 14336
    s_cselect_b32 s66, s66, s23
    s_add_u32 s67, s67, s62
    s_sub_u32 s23, s67, 14336
    s_cselect_b32 s67, s67, s23
    s_add_u32 s68, s68, s62
    s_sub_u32 s23, s68, 14336
    s_cselect_b32 s68, s68, s23
    s_add_u32 s69, s69, s62
    s_sub_u32 s23, s69, 14336
    s_cselect_b32 s69, s69, s23
    s_add_u32 s70, s70, s62
    s_sub_u32 s23, s70, 14336
    s_cselect_b32 s70, s70, s23
    s_add_u32 s71, s71, s62
    s_sub_u32 s23, s71, 14336
    s_cselect_b32 s71, s71, s23
    s_add_u32 s72, s72, s62
    s_sub_u32 s23, s72, 14336
    s_cselect_b32 s72, s72, s23
    s_add_u32 s73, s73, s62
    s_sub_u32 s23, s73, 14336
    s_cselect_b32 s73, s73, s23
    s_add_u32 s74, s74, s62
    s_sub_u32 s23, s74, 14336
    s_cselect_b32 s74, s74, s23
    s_add_u32 s75, s75, s62
    s_sub_u32 s23, s75, 14336
    s_cselect_b32 s75, s75, s23
    s_add_u32 s76, s76, s62
    s_sub_u32 s23, s76, 14336
    s_cselect_b32 s76, s76, s23
    s_add_u32 s77, s77, s62
    s_sub_u32 s23, s77, 14336
    s_cselect_b32 s77, s77, s23
    v_lshrrev_b32 v3, 4, v1
    v_bfe_u32 v2, v1, 2, 2
    v_and_b32 v4, 3, v1
    v_lshl_add_u32 v7, v3, 2, v2
    v_bfe_u32 v5, v7, 1, 2
    v_lshlrev_b32 v7, 7, v7
    v_lshl_add_u32 v7, v4, 3, v7
    v_add_u32 v7, s57, v7
    v_lshl_add_u32 v244, v5, 5, v7
    v_xor_b32 v245, 32, v244
    v_xor_b32 v246, 64, v244
    v_xor_b32 v247, 96, v244
    v_add_u32 v248, 65536, v244
    v_add_u32 v249, 65536, v245
    v_add_u32 v250, 65536, v246
    v_add_u32 v251, 65536, v247
    v_add_u32 v252, 131072, v244
    v_add_u32 v253, 131072, v245
    v_add_u32 v254, 131072, v246
    v_add_u32 v255, 131072, v247
    s_lshl_b32 s49, s46, 2
    s_add_u32 s49, s49, s20
    s_lshl_b32 s49, s49, 7
    s_add_u32 s49, s49, 7340032
    s_lshl_b32 s23, s47, 7
    v_and_b32 v9, 15, v0
    v_lshl_add_u32 v9, v9, 3, s23
    global_load_dwordx2 v[60:61], v9, s[12:13]
    s_sub_u32 s60, s22, 28
    s_lshl_b32 s60, s60, 2
    s_add_u32 s60, s60, s20
    v_lshlrev_b32 v34, 7, v1
    s_lshr_b32 s61, s60, 2
    s_mul_i32 s61, s61, 458752
    s_and_b32 s23, s60, 3
    s_lshl_b32 s23, s23, 13
    s_add_u32 s61, s61, s23
    s_add_u32 s53, s62, 9216
    s_sub_u32 s23, s53, 14336
    s_cselect_b32 s53, s53, s23
    s_lshl_b32 s53, s53, 5
    s_add_u32 s53, s53, s61
    buffer_load_dword v44, v34, s[32:35], s53 offen
    global_load_dword v30, v31, s[16:17] sc1
    s_lshl_b32 s53, s64, 5
    s_add_u32 m0, s57, 98304
    s_add_u32 s53, s53, s56
    buffer_load_dwordx4 v20, s[32:35], s53 offen offset:0 lds
    buffer_load_dwordx4 v21, s[32:35], s53 offen offset:1024 lds
    buffer_load_dwordx4 v22, s[32:35], s53 offen offset:2048 lds
    buffer_load_dwordx4 v23, s[32:35], s53 offen offset:3072 lds
    s_lshl_b32 s53, s65, 5
    s_add_u32 m0, s57, 102400
    s_add_u32 s53, s53, s56
    buffer_load_dwordx4 v20, s[32:35], s53 offen offset:0 lds
    buffer_load_dwordx4 v21, s[32:35], s53 offen offset:1024 lds
    buffer_load_dwordx4 v22, s[32:35], s53 offen offset:2048 lds
    buffer_load_dwordx4 v23, s[32:35], s53 offen offset:3072 lds
    s_lshl_b32 s53, s66, 5
    s_add_u32 m0, s57, 131072
    s_add_u32 s53, s53, s56
    buffer_load_dwordx4 v20, s[32:35], s53 offen offset:0 lds
    buffer_load_dwordx4 v21, s[32:35], s53 offen offset:1024 lds
    buffer_load_dwordx4 v22, s[32:35], s53 offen offset:2048 lds
    buffer_load_dwordx4 v23, s[32:35], s53 offen offset:3072 lds
    s_lshl_b32 s53, s67, 5
    s_add_u32 m0, s57, 135168
    s_add_u32 s53, s53, s56
    buffer_load_dwordx4 v20, s[32:35], s53 offen offset:0 lds
    buffer_load_dwordx4 v21, s[32:35], s53 offen offset:1024 lds
    buffer_load_dwordx4 v22, s[32:35], s53 offen offset:2048 lds
    buffer_load_dwordx4 v23, s[32:35], s53 offen offset:3072 lds
    s_lshl_b32 s53, s68, 5
    s_add_u32 m0, s57, 0
    s_add_u32 s53, s53, s56
    buffer_load_dwordx4 v20, s[32:35], s53 offen offset:0 lds
    buffer_load_dwordx4 v21, s[32:35], s53 offen offset:1024 lds
    buffer_load_dwordx4 v22, s[32:35], s53 offen offset:2048 lds
    buffer_load_dwordx4 v23, s[32:35], s53 offen offset:3072 lds
    s_lshl_b32 s53, s69, 5
    s_add_u32 m0, s57, 4096
    s_add_u32 s53, s53, s56
    buffer_load_dwordx4 v20, s[32:35], s53 offen offset:0 lds
    buffer_load_dwordx4 v21, s[32:35], s53 offen offset:1024 lds
    buffer_load_dwordx4 v22, s[32:35], s53 offen offset:2048 lds
    buffer_load_dwordx4 v23, s[32:35], s53 offen offset:3072 lds
    s_lshl_b32 s53, s70, 5
    s_add_u32 m0, s57, 32768
    s_add_u32 s53, s53, s56
    buffer_load_dwordx4 v20, s[32:35], s53 offen offset:0 lds
    buffer_load_dwordx4 v21, s[32:35], s53 offen offset:1024 lds
    buffer_load_dwordx4 v22, s[32:35], s53 offen offset:2048 lds
    buffer_load_dwordx4 v23, s[32:35], s53 offen offset:3072 lds
    s_lshl_b32 s53, s71, 5
    s_add_u32 m0, s57, 36864
    s_add_u32 s53, s53, s56
    buffer_load_dwordx4 v20, s[32:35], s53 offen offset:0 lds
    buffer_load_dwordx4 v21, s[32:35], s53 offen offset:1024 lds
    buffer_load_dwordx4 v22, s[32:35], s53 offen offset:2048 lds
    buffer_load_dwordx4 v23, s[32:35], s53 offen offset:3072 lds
    s_lshl_b32 s53, s72, 5
    s_add_u32 m0, s57, 65536
    s_add_u32 s53, s53, s56
    buffer_load_dwordx4 v20, s[32:35], s53 offen offset:0 lds
    buffer_load_dwordx4 v21, s[32:35], s53 offen offset:1024 lds
    buffer_load_dwordx4 v22, s[32:35], s53 offen offset:2048 lds
    buffer_load_dwordx4 v23, s[32:35], s53 offen offset:3072 lds
    s_lshl_b32 s53, s73, 5
    s_add_u32 m0, s57, 69632
    s_add_u32 s53, s53, s56
    buffer_load_dwordx4 v20, s[32:35], s53 offen offset:0 lds
    buffer_load_dwordx4 v21, s[32:35], s53 offen offset:1024 lds
    buffer_load_dwordx4 v22, s[32:35], s53 offen offset:2048 lds
    buffer_load_dwordx4 v23, s[32:35], s53 offen offset:3072 lds
    s_waitcnt vmcnt(36)
    ds_read_b64_tr_b16 a[0:1], v248 offset:32768
    ds_read_b64_tr_b16 a[2:3], v248 offset:34816
    ds_read_b64_tr_b16 a[4:5], v249 offset:32768
    ds_read_b64_tr_b16 a[6:7], v249 offset:34816
    ds_read_b64_tr_b16 a[8:9], v250 offset:32768
    ds_read_b64_tr_b16 a[10:11], v250 offset:34816
    ds_read_b64_tr_b16 a[12:13], v251 offset:32768
    ds_read_b64_tr_b16 a[14:15], v251 offset:34816
    v_and_b32 v8, 15, v1
    v_lshrrev_b32 v9, 4, v1
    v_and_b32 v10, 7, v1
    v_xor_b32 v9, v9, v10
    v_lshlrev_b32 v9, 4, v9
    v_lshl_add_u32 v9, v8, 8, v9
    v_add_u32 v2, s57, v9
    v_xor_b32 v3, 64, v2
    v_lshrrev_b32 v8, 4, v0
    v_and_b32 v9, 15, v0
    v_and_b32 v10, 7, v8
    v_xor_b32 v10, v10, v9
    v_lshlrev_b32 v10, 4, v10
    v_lshl_add_u32 v6, v8, 8, v10
    s_lshl_b32 s23, s46, 16
    s_lshl_b32 s55, s47, 7
    s_add_u32 s58, s23, s55
    v_lshlrev_b32 v7, 10, v8
    v_lshl_add_u32 v7, v9, 3, v7
    v_lshlrev_b32 v12, 16, v60
    v_and_b32 v13, 0xffff0000, v60
    v_lshlrev_b32 v14, 16, v61
    v_and_b32 v15, 0xffff0000, v61
    s_mul_i32 s59, s46, 229376
    s_mul_i32 s23, s20, 14336
    s_add_u32 s59, s59, s23
    s_mov_b32 s23, 262144
L_tagi_chk:
    v_readfirstlane_b32 s48, v30
    s_nop 0
    s_cmp_lg_u32 s48, 0
    s_cbranch_scc1 L_tagi_ok
    s_sub_u32 s23, s23, 1
    s_cmp_eq_u32 s23, 0
    s_cbranch_scc1 L_tagi_ok
    s_sleep 2
    global_load_dword v30, v31, s[16:17] sc1
    s_waitcnt vmcnt(0)
    s_branch L_tagi_chk
L_tagi_ok:
    s_waitcnt vmcnt(32)
    ds_read_b64_tr_b16 a[16:17], v248 offset:36864
    ds_read_b64_tr_b16 a[18:19], v248 offset:38912
    ds_read_b64_tr_b16 a[20:21], v249 offset:36864
    ds_read_b64_tr_b16 a[22:23], v249 offset:38912
    ds_read_b64_tr_b16 a[24:25], v250 offset:36864
    ds_read_b64_tr_b16 a[26:27], v250 offset:38912
    ds_read_b64_tr_b16 a[28:29], v251 offset:36864
    ds_read_b64_tr_b16 a[30:31], v251 offset:38912
    s_waitcnt lgkmcnt(0)
    s_lshl_b32 s53, s74, 5
    s_add_u32 m0, s57, 98304
    s_add_u32 s53, s53, s56
    buffer_load_dwordx4 v20, s[32:35], s53 offen offset:0 lds
    buffer_load_dwordx4 v21, s[32:35], s53 offen offset:1024 lds
    buffer_load_dwordx4 v22, s[32:35], s53 offen offset:2048 lds
    buffer_load_dwordx4 v23, s[32:35], s53 offen offset:3072 lds
    s_lshl_b32 s53, s75, 5
    s_add_u32 m0, s57, 102400
    s_add_u32 s53, s53, s56
    buffer_load_dwordx4 v20, s[32:35], s53 offen offset:0 lds
    buffer_load_dwordx4 v21, s[32:35], s53 offen offset:1024 lds
    buffer_load_dwordx4 v22, s[32:35], s53 offen offset:2048 lds
    buffer_load_dwordx4 v23, s[32:35], s53 offen offset:3072 lds
    s_waitcnt vmcnt(36)
    ds_read_b64_tr_b16 a[32:33], v252 offset:0
    ds_read_b64_tr_b16 a[34:35], v252 offset:2048
    ds_read_b64_tr_b16 a[36:37], v253 offset:0
    ds_read_b64_tr_b16 a[38:39], v253 offset:2048
    ds_read_b64_tr_b16 a[40:41], v254 offset:0
    ds_read_b64_tr_b16 a[42:43], v254 offset:2048
    ds_read_b64_tr_b16 a[44:45], v255 offset:0
    ds_read_b64_tr_b16 a[46:47], v255 offset:2048
    s_waitcnt vmcnt(32)
    ds_read_b64_tr_b16 a[48:49], v252 offset:4096
    ds_read_b64_tr_b16 a[50:51], v252 offset:6144
    ds_read_b64_tr_b16 a[52:53], v253 offset:4096
    ds_read_b64_tr_b16 a[54:55], v253 offset:6144
    ds_read_b64_tr_b16 a[56:57], v254 offset:4096
    ds_read_b64_tr_b16 a[58:59], v254 offset:6144
    ds_read_b64_tr_b16 a[60:61], v255 offset:4096
    ds_read_b64_tr_b16 a[62:63], v255 offset:6144
    s_waitcnt lgkmcnt(0)
    s_lshl_b32 s53, s76, 5
    s_add_u32 m0, s57, 131072
    s_add_u32 s53, s53, s56
    buffer_load_dwordx4 v20, s[32:35], s53 offen offset:0 lds
    buffer_load_dwordx4 v21, s[32:35], s53 offen offset:1024 lds
    buffer_load_dwordx4 v22, s[32:35], s53 offen offset:2048 lds
    buffer_load_dwordx4 v23, s[32:35], s53 offen offset:3072 lds
    s_lshl_b32 s53, s77, 5
    s_add_u32 m0, s57, 135168
    s_add_u32 s53, s53, s56
    buffer_load_dwordx4 v20, s[32:35], s53 offen offset:0 lds
    buffer_load_dwordx4 v21, s[32:35], s53 offen offset:1024 lds
    buffer_load_dwordx4 v22, s[32:35], s53 offen offset:2048 lds
    buffer_load_dwordx4 v23, s[32:35], s53 offen offset:3072 lds
    s_waitcnt vmcnt(36)
    ds_read_b64_tr_b16 a[64:65], v244 offset:0
    ds_read_b64_tr_b16 a[66:67], v244 offset:2048
    ds_read_b64_tr_b16 a[68:69], v245 offset:0
    ds_read_b64_tr_b16 a[70:71], v245 offset:2048
    ds_read_b64_tr_b16 a[72:73], v246 offset:0
    ds_read_b64_tr_b16 a[74:75], v246 offset:2048
    ds_read_b64_tr_b16 a[76:77], v247 offset:0
    ds_read_b64_tr_b16 a[78:79], v247 offset:2048
    s_waitcnt vmcnt(32)
    ds_read_b64_tr_b16 a[80:81], v244 offset:4096
    ds_read_b64_tr_b16 a[82:83], v244 offset:6144
    ds_read_b64_tr_b16 a[84:85], v245 offset:4096
    ds_read_b64_tr_b16 a[86:87], v245 offset:6144
    ds_read_b64_tr_b16 a[88:89], v246 offset:4096
    ds_read_b64_tr_b16 a[90:91], v246 offset:6144
    ds_read_b64_tr_b16 a[92:93], v247 offset:4096
    ds_read_b64_tr_b16 a[94:95], v247 offset:6144
    s_waitcnt vmcnt(28)
    ds_read_b64_tr_b16 a[96:97], v244 offset:32768
    ds_read_b64_tr_b16 a[98:99], v244 offset:34816
    ds_read_b64_tr_b16 a[100:101], v245 offset:32768
    ds_read_b64_tr_b16 a[102:103], v245 offset:34816
    ds_read_b64_tr_b16 a[104:105], v246 offset:32768
    ds_read_b64_tr_b16 a[106:107], v246 offset:34816
    ds_read_b64_tr_b16 a[108:109], v247 offset:32768
    ds_read_b64_tr_b16 a[110:111], v247 offset:34816
    s_waitcnt vmcnt(24)
    ds_read_b64_tr_b16 a[112:113], v244 offset:36864
    ds_read_b64_tr_b16 a[114:115], v244 offset:38912
    ds_read_b64_tr_b16 a[116:117], v245 offset:36864
    ds_read_b64_tr_b16 a[118:119], v245 offset:38912
    ds_read_b64_tr_b16 a[120:121], v246 offset:36864
    ds_read_b64_tr_b16 a[122:123], v246 offset:38912
    ds_read_b64_tr_b16 a[124:125], v247 offset:36864
    ds_read_b64_tr_b16 a[126:127], v247 offset:38912
    s_waitcnt vmcnt(20)
    ds_read_b64_tr_b16 a[128:129], v248 offset:0
    ds_read_b64_tr_b16 a[130:131], v248 offset:2048
    ds_read_b64_tr_b16 a[132:133], v249 offset:0
    ds_read_b64_tr_b16 a[134:135], v249 offset:2048
    ds_read_b64_tr_b16 a[136:137], v250 offset:0
    ds_read_b64_tr_b16 a[138:139], v250 offset:2048
    ds_read_b64_tr_b16 a[140:141], v251 offset:0
    ds_read_b64_tr_b16 a[142:143], v251 offset:2048
    s_waitcnt vmcnt(16)
    ds_read_b64_tr_b16 a[144:145], v248 offset:4096
    ds_read_b64_tr_b16 a[146:147], v248 offset:6144
    ds_read_b64_tr_b16 a[148:149], v249 offset:4096
    ds_read_b64_tr_b16 a[150:151], v249 offset:6144
    ds_read_b64_tr_b16 a[152:153], v250 offset:4096
    ds_read_b64_tr_b16 a[154:155], v250 offset:6144
    ds_read_b64_tr_b16 a[156:157], v251 offset:4096
    ds_read_b64_tr_b16 a[158:159], v251 offset:6144
    s_load_dwordx8 s[4:11], s[18:19], s49 glc
    s_waitcnt vmcnt(12)
    ds_read_b64_tr_b16 a[160:161], v248 offset:32768
    ds_read_b64_tr_b16 a[162:163], v248 offset:34816
    ds_read_b64_tr_b16 a[164:165], v249 offset:32768
    ds_read_b64_tr_b16 a[166:167], v249 offset:34816
    ds_read_b64_tr_b16 a[168:169], v250 offset:32768
    ds_read_b64_tr_b16 a[170:171], v250 offset:34816
    ds_read_b64_tr_b16 a[172:173], v251 offset:32768
    ds_read_b64_tr_b16 a[174:175], v251 offset:34816
L_join:
    s_mov_b32 s23, 262144
L_poll_chk:
    s_waitcnt lgkmcnt(0)
    s_xor_b32 s4, s4, s48
    s_xor_b32 s5, s5, s48
    s_xor_b32 s6, s6, s48
    s_xor_b32 s7, s7, s48
    s_xor_b32 s8, s8, s48
    s_xor_b32 s9, s9, s48
    s_xor_b32 s10, s10, s48
    s_or_b32 s4, s4, s5
    s_or_b32 s4, s4, s6
    s_or_b32 s4, s4, s7
    s_or_b32 s4, s4, s8
    s_or_b32 s4, s4, s9
    s_or_b32 s4, s4, s10
    s_cbranch_scc0 L_poll_ok
    s_sub_u32 s23, s23, 1
    s_cmp_eq_u32 s23, 0
    s_cbranch_scc1 L_poll_ok
    s_load_dwordx8 s[4:11], s[18:19], s49 glc
    s_branch L_poll_chk
L_poll_ok:
    s_add_u32 s60, s59, s64
    buffer_load_dwordx4 v[112:115], v11, s[36:39], s60 offen offset:0 sc1
    s_add_u32 s60, s59, s65
    buffer_load_dwordx4 v[116:119], v11, s[36:39], s60 offen offset:0 sc1
    s_add_u32 s60, s59, s66
    buffer_load_dwordx4 v[120:123], v11, s[36:39], s60 offen offset:0 sc1
    s_add_u32 s60, s59, s67
    buffer_load_dwordx4 v[124:127], v11, s[36:39], s60 offen offset:0 sc1
    s_add_u32 s60, s59, s68
    buffer_load_dwordx4 v[128:131], v11, s[36:39], s60 offen offset:0 sc1
    s_add_u32 s60, s59, s69
    buffer_load_dwordx4 v[132:135], v11, s[36:39], s60 offen offset:0 sc1
    s_add_u32 s60, s59, s70
    buffer_load_dwordx4 v[136:139], v11, s[36:39], s60 offen offset:0 sc1
    s_add_u32 s60, s59, s71
    buffer_load_dwordx4 v[140:143], v11, s[36:39], s60 offen offset:0 sc1
    s_add_u32 s60, s59, s72
    buffer_load_dwordx4 v[144:147], v11, s[36:39], s60 offen offset:0 sc1
    s_add_u32 s60, s59, s73
    buffer_load_dwordx4 v[148:151], v11, s[36:39], s60 offen offset:0 sc1
    s_add_u32 s60, s59, s74
    buffer_load_dwordx4 v[152:155], v11, s[36:39], s60 offen offset:0 sc1
    s_add_u32 s60, s59, s75
    buffer_load_dwordx4 v[156:159], v11, s[36:39], s60 offen offset:0 sc1
    s_waitcnt vmcnt(11)
    v_mfma_f32_16x16x32_bf16 v[32:35], a[0:3], v[112:115], 0
    ds_read_b64_tr_b16 a[176:177], v248 offset:36864
    v_mfma_f32_16x16x32_bf16 v[48:51], a[4:7], v[112:115], 0
    ds_read_b64_tr_b16 a[178:179], v248 offset:38912
    s_add_u32 s60, s59, s76
    v_mfma_f32_16x16x32_bf16 v[64:67], a[8:11], v[112:115], 0
    buffer_load_dwordx4 v[160:163], v11, s[36:39], s60 offen offset:0 sc1
    v_mfma_f32_16x16x32_bf16 v[80:83], a[12:15], v[112:115], 0
    ds_read_b64_tr_b16 a[180:181], v249 offset:36864
    s_waitcnt vmcnt(11)
    v_mfma_f32_16x16x32_bf16 v[32:35], a[16:19], v[116:119], v[32:35]
    ds_read_b64_tr_b16 a[182:183], v249 offset:38912
    v_mfma_f32_16x16x32_bf16 v[48:51], a[20:23], v[116:119], v[48:51]
    ds_read_b64_tr_b16 a[184:185], v250 offset:36864
    s_add_u32 s60, s59, s77
    v_mfma_f32_16x16x32_bf16 v[64:67], a[24:27], v[116:119], v[64:67]
    buffer_load_dwordx4 v[164:167], v11, s[36:39], s60 offen offset:0 sc1
    v_mfma_f32_16x16x32_bf16 v[80:83], a[28:31], v[116:119], v[80:83]
    ds_read_b64_tr_b16 a[186:187], v250 offset:38912
    s_waitcnt vmcnt(11)
    v_mfma_f32_16x16x32_bf16 v[32:35], a[32:35], v[120:123], v[32:35]
    ds_read_b64_tr_b16 a[188:189], v251 offset:36864
    v_mfma_f32_16x16x32_bf16 v[48:51], a[36:39], v[120:123], v[48:51]
    ds_read_b64_tr_b16 a[190:191], v251 offset:38912
    s_add_u32 s60, s59, s64
    v_mfma_f32_16x16x32_bf16 v[64:67], a[40:43], v[120:123], v[64:67]
    buffer_load_dwordx4 v[168:171], v27, s[36:39], s60 offen offset:0 sc1
    v_mfma_f32_16x16x32_bf16 v[80:83], a[44:47], v[120:123], v[80:83]
    ds_read_b64_tr_b16 a[192:193], v252 offset:0
    s_waitcnt vmcnt(11)
    v_mfma_f32_16x16x32_bf16 v[32:35], a[48:51], v[124:127], v[32:35]
    ds_read_b64_tr_b16 a[194:195], v252 offset:2048
    v_mfma_f32_16x16x32_bf16 v[48:51], a[52:55], v[124:127], v[48:51]
    ds_read_b64_tr_b16 a[196:197], v253 offset:0
    s_add_u32 s60, s59, s65
    v_mfma_f32_16x16x32_bf16 v[64:67], a[56:59], v[124:127], v[64:67]
    buffer_load_dwordx4 v[172:175], v27, s[36:39], s60 offen offset:0 sc1
    v_mfma_f32_16x16x32_bf16 v[80:83], a[60:63], v[124:127], v[80:83]
    ds_read_b64_tr_b16 a[198:199], v253 offset:2048
    s_waitcnt vmcnt(11)
    v_mfma_f32_16x16x32_bf16 v[32:35], a[64:67], v[128:131], v[32:35]
    ds_read_b64_tr_b16 a[200:201], v254 offset:0
    v_mfma_f32_16x16x32_bf16 v[48:51], a[68:71], v[128:131], v[48:51]
    ds_read_b64_tr_b16 a[202:203], v254 offset:2048
    s_add_u32 s60, s59, s66
    v_mfma_f32_16x16x32_bf16 v[64:67], a[72:75], v[128:131], v[64:67]
    buffer_load_dwordx4 v[176:179], v27, s[36:39], s60 offen offset:0 sc1
    v_mfma_f32_16x16x32_bf16 v[80:83], a[76:79], v[128:131], v[80:83]
    ds_read_b64_tr_b16 a[204:205], v255 offset:0
    s_waitcnt vmcnt(11)
    v_mfma_f32_16x16x32_bf16 v[32:35], a[80:83], v[132:135], v[32:35]
    ds_read_b64_tr_b16 a[206:207], v255 offset:2048
    v_mfma_f32_16x16x32_bf16 v[48:51], a[84:87], v[132:135], v[48:51]
    ds_read_b64_tr_b16 a[208:209], v252 offset:4096
    s_add_u32 s60, s59, s67
    v_mfma_f32_16x16x32_bf16 v[64:67], a[88:91], v[132:135], v[64:67]
    buffer_load_dwordx4 v[180:183], v27, s[36:39], s60 offen offset:0 sc1
    v_mfma_f32_16x16x32_bf16 v[80:83], a[92:95], v[132:135], v[80:83]
    ds_read_b64_tr_b16 a[210:211], v252 offset:6144
    s_waitcnt vmcnt(11)
    v_mfma_f32_16x16x32_bf16 v[32:35], a[96:99], v[136:139], v[32:35]
    ds_read_b64_tr_b16 a[212:213], v253 offset:4096
    v_mfma_f32_16x16x32_bf16 v[48:51], a[100:103], v[136:139], v[48:51]
    ds_read_b64_tr_b16 a[214:215], v253 offset:6144
    s_add_u32 s60, s59, s68
    v_mfma_f32_16x16x32_bf16 v[64:67], a[104:107], v[136:139], v[64:67]
    buffer_load_dwordx4 v[184:187], v27, s[36:39], s60 offen offset:0 sc1
    v_mfma_f32_16x16x32_bf16 v[80:83], a[108:111], v[136:139], v[80:83]
    ds_read_b64_tr_b16 a[216:217], v254 offset:4096
    s_waitcnt vmcnt(11)
    v_mfma_f32_16x16x32_bf16 v[32:35], a[112:115], v[140:143], v[32:35]
    ds_read_b64_tr_b16 a[218:219], v254 offset:6144
    v_mfma_f32_16x16x32_bf16 v[48:51], a[116:119], v[140:143], v[48:51]
    ds_read_b64_tr_b16 a[220:221], v255 offset:4096
    s_add_u32 s60, s59, s69
    v_mfma_f32_16x16x32_bf16 v[64:67], a[120:123], v[140:143], v[64:67]
    buffer_load_dwordx4 v[188:191], v27, s[36:39], s60 offen offset:0 sc1
    v_mfma_f32_16x16x32_bf16 v[80:83], a[124:127], v[140:143], v[80:83]
    ds_read_b64_tr_b16 a[222:223], v255 offset:6144
    s_waitcnt vmcnt(11)
    v_mfma_f32_16x16x32_bf16 v[32:35], a[128:131], v[144:147], v[32:35]
    v_mfma_f32_16x16x32_bf16 v[48:51], a[132:135], v[144:147], v[48:51]
    s_add_u32 s60, s59, s70
    v_mfma_f32_16x16x32_bf16 v[64:67], a[136:139], v[144:147], v[64:67]
    buffer_load_dwordx4 v[192:195], v27, s[36:39], s60 offen offset:0 sc1
    v_mfma_f32_16x16x32_bf16 v[80:83], a[140:143], v[144:147], v[80:83]
    s_waitcnt vmcnt(11)
    v_mfma_f32_16x16x32_bf16 v[32:35], a[144:147], v[148:151], v[32:35]
    v_mfma_f32_16x16x32_bf16 v[48:51], a[148:151], v[148:151], v[48:51]
    s_add_u32 s60, s59, s71
    v_mfma_f32_16x16x32_bf16 v[64:67], a[152:155], v[148:151], v[64:67]
    buffer_load_dwordx4 v[196:199], v27, s[36:39], s60 offen offset:0 sc1
    v_mfma_f32_16x16x32_bf16 v[80:83], a[156:159], v[148:151], v[80:83]
    s_waitcnt vmcnt(11)
    v_mfma_f32_16x16x32_bf16 v[32:35], a[160:163], v[152:155], v[32:35]
    v_mfma_f32_16x16x32_bf16 v[48:51], a[164:167], v[152:155], v[48:51]
    s_add_u32 s60, s59, s72
    v_mfma_f32_16x16x32_bf16 v[64:67], a[168:171], v[152:155], v[64:67]
    buffer_load_dwordx4 v[200:203], v27, s[36:39], s60 offen offset:0 sc1
    v_mfma_f32_16x16x32_bf16 v[80:83], a[172:175], v[152:155], v[80:83]
    s_waitcnt lgkmcnt(0)
    s_waitcnt vmcnt(11)
    v_mfma_f32_16x16x32_bf16 v[32:35], a[176:179], v[156:159], v[32:35]
    v_mfma_f32_16x16x32_bf16 v[48:51], a[180:183], v[156:159], v[48:51]
    s_add_u32 s60, s59, s73
    v_mfma_f32_16x16x32_bf16 v[64:67], a[184:187], v[156:159], v[64:67]
    buffer_load_dwordx4 v[204:207], v27, s[36:39], s60 offen offset:0 sc1
    v_mfma_f32_16x16x32_bf16 v[80:83], a[188:191], v[156:159], v[80:83]
    s_waitcnt lgkmcnt(0)
    s_waitcnt vmcnt(11)
    v_mfma_f32_16x16x32_bf16 v[32:35], a[192:195], v[160:163], v[32:35]
    v_mfma_f32_16x16x32_bf16 v[48:51], a[196:199], v[160:163], v[48:51]
    s_add_u32 s60, s59, s74
    v_mfma_f32_16x16x32_bf16 v[64:67], a[200:203], v[160:163], v[64:67]
    buffer_load_dwordx4 v[208:211], v27, s[36:39], s60 offen offset:0 sc1
    v_mfma_f32_16x16x32_bf16 v[80:83], a[204:207], v[160:163], v[80:83]
    s_waitcnt lgkmcnt(0)
    s_waitcnt vmcnt(11)
    v_mfma_f32_16x16x32_bf16 v[32:35], a[208:211], v[164:167], v[32:35]
    v_mfma_f32_16x16x32_bf16 v[48:51], a[212:215], v[164:167], v[48:51]
    s_add_u32 s60, s59, s75
    v_mfma_f32_16x16x32_bf16 v[64:67], a[216:219], v[164:167], v[64:67]
    buffer_load_dwordx4 v[212:215], v27, s[36:39], s60 offen offset:0 sc1
    v_mfma_f32_16x16x32_bf16 v[80:83], a[220:223], v[164:167], v[80:83]
    s_waitcnt vmcnt(11)
    v_mfma_f32_16x16x32_bf16 v[36:39], a[0:3], v[168:171], 0
    v_mfma_f32_16x16x32_bf16 v[52:55], a[4:7], v[168:171], 0
    s_add_u32 s60, s59, s76
    v_mfma_f32_16x16x32_bf16 v[68:71], a[8:11], v[168:171], 0
    buffer_load_dwordx4 v[216:219], v27, s[36:39], s60 offen offset:0 sc1
    v_mfma_f32_16x16x32_bf16 v[84:87], a[12:15], v[168:171], 0
    s_waitcnt vmcnt(11)
    v_mfma_f32_16x16x32_bf16 v[36:39], a[16:19], v[172:175], v[36:39]
    v_mfma_f32_16x16x32_bf16 v[52:55], a[20:23], v[172:175], v[52:55]
    s_add_u32 s60, s59, s77
    v_mfma_f32_16x16x32_bf16 v[68:71], a[24:27], v[172:175], v[68:71]
    buffer_load_dwordx4 v[220:223], v27, s[36:39], s60 offen offset:0 sc1
    v_mfma_f32_16x16x32_bf16 v[84:87], a[28:31], v[172:175], v[84:87]
    s_waitcnt vmcnt(11)
    v_mfma_f32_16x16x32_bf16 v[36:39], a[32:35], v[176:179], v[36:39]
    ds_write_b128 v2, v[32:35] offset:0
    v_mfma_f32_16x16x32_bf16 v[52:55], a[36:39], v[176:179], v[52:55]
    s_add_u32 s60, s59, s64
    v_mfma_f32_16x16x32_bf16 v[68:71], a[40:43], v[176:179], v[68:71]
    buffer_load_dwordx4 v[224:227], v28, s[36:39], s60 offen offset:0 sc1
    v_mfma_f32_16x16x32_bf16 v[84:87], a[44:47], v[176:179], v[84:87]
    s_waitcnt vmcnt(11)
    v_mfma_f32_16x16x32_bf16 v[36:39], a[48:51], v[180:183], v[36:39]
    ds_write_b128 v3, v[48:51] offset:0
    v_mfma_f32_16x16x32_bf16 v[52:55], a[52:55], v[180:183], v[52:55]
    s_add_u32 s60, s59, s65
    v_mfma_f32_16x16x32_bf16 v[68:71], a[56:59], v[180:183], v[68:71]
    buffer_load_dwordx4 v[228:231], v28, s[36:39], s60 offen offset:0 sc1
    v_mfma_f32_16x16x32_bf16 v[84:87], a[60:63], v[180:183], v[84:87]
    s_waitcnt vmcnt(11)
    v_mfma_f32_16x16x32_bf16 v[36:39], a[64:67], v[184:187], v[36:39]
    ds_write_b128 v2, v[64:67] offset:128
    v_mfma_f32_16x16x32_bf16 v[52:55], a[68:71], v[184:187], v[52:55]
    s_add_u32 s60, s59, s66
    v_mfma_f32_16x16x32_bf16 v[68:71], a[72:75], v[184:187], v[68:71]
    buffer_load_dwordx4 v[232:235], v28, s[36:39], s60 offen offset:0 sc1
    v_mfma_f32_16x16x32_bf16 v[84:87], a[76:79], v[184:187], v[84:87]
    s_waitcnt vmcnt(11)
    v_mfma_f32_16x16x32_bf16 v[36:39], a[80:83], v[188:191], v[36:39]
    ds_write_b128 v3, v[80:83] offset:128
    v_mfma_f32_16x16x32_bf16 v[52:55], a[84:87], v[188:191], v[52:55]
    s_add_u32 s60, s59, s67
    v_mfma_f32_16x16x32_bf16 v[68:71], a[88:91], v[188:191], v[68:71]
    buffer_load_dwordx4 v[236:239], v28, s[36:39], s60 offen offset:0 sc1
    v_mfma_f32_16x16x32_bf16 v[84:87], a[92:95], v[188:191], v[84:87]
    s_waitcnt vmcnt(11)
    v_mfma_f32_16x16x32_bf16 v[36:39], a[96:99], v[192:195], v[36:39]
    v_mfma_f32_16x16x32_bf16 v[52:55], a[100:103], v[192:195], v[52:55]
    s_add_u32 s60, s59, s68
    v_mfma_f32_16x16x32_bf16 v[68:71], a[104:107], v[192:195], v[68:71]
    buffer_load_dwordx4 a[224:227], v28, s[36:39], s60 offen offset:0 sc1
    v_mfma_f32_16x16x32_bf16 v[84:87], a[108:111], v[192:195], v[84:87]
    s_waitcnt lgkmcnt(0)
    s_barrier
    s_waitcnt vmcnt(11)
    v_mfma_f32_16x16x32_bf16 v[36:39], a[112:115], v[196:199], v[36:39]
    ds_read_b128 v[96:99], v6 offset:0
    ds_read_b128 v[100:103], v6 offset:8192
    v_mfma_f32_16x16x32_bf16 v[52:55], a[116:119], v[196:199], v[52:55]
    ds_read_b128 v[104:107], v6 offset:16384
    ds_read_b128 v[108:111], v6 offset:24576
    s_add_u32 s60, s59, s69
    v_mfma_f32_16x16x32_bf16 v[68:71], a[120:123], v[196:199], v[68:71]
    buffer_load_dwordx4 a[228:231], v28, s[36:39], s60 offen offset:0 sc1
    v_mfma_f32_16x16x32_bf16 v[84:87], a[124:127], v[196:199], v[84:87]
    s_waitcnt lgkmcnt(2)
    s_waitcnt vmcnt(11)
    v_mfma_f32_16x16x32_bf16 v[36:39], a[128:131], v[200:203], v[36:39]
    v_add_f32 v96, v96, v100
    v_add_f32 v97, v97, v101
    v_mfma_f32_16x16x32_bf16 v[52:55], a[132:135], v[200:203], v[52:55]
    v_add_f32 v98, v98, v102
    v_add_f32 v99, v99, v103
    s_add_u32 s60, s59, s70
    v_mfma_f32_16x16x32_bf16 v[68:71], a[136:139], v[200:203], v[68:71]
    buffer_load_dwordx4 a[232:235], v28, s[36:39], s60 offen offset:0 sc1
    v_mfma_f32_16x16x32_bf16 v[84:87], a[140:143], v[200:203], v[84:87]
    s_waitcnt lgkmcnt(0)
    s_waitcnt vmcnt(11)
    v_mfma_f32_16x16x32_bf16 v[36:39], a[144:147], v[204:207], v[36:39]
    v_add_f32 v104, v104, v108
    v_add_f32 v105, v105, v109
    v_mfma_f32_16x16x32_bf16 v[52:55], a[148:151], v[204:207], v[52:55]
    v_add_f32 v106, v106, v110
    v_add_f32 v107, v107, v111
    s_add_u32 s60, s59, s71
    v_mfma_f32_16x16x32_bf16 v[68:71], a[152:155], v[204:207], v[68:71]
    buffer_load_dwordx4 a[236:239], v28, s[36:39], s60 offen offset:0 sc1
    v_mfma_f32_16x16x32_bf16 v[84:87], a[156:159], v[204:207], v[84:87]
    v_add_f32 v96, v96, v12
    s_waitcnt vmcnt(11)
    v_mfma_f32_16x16x32_bf16 v[36:39], a[160:163], v[208:211], v[36:39]
    v_add_f32 v97, v97, v13
    v_add_f32 v98, v98, v14
    v_mfma_f32_16x16x32_bf16 v[52:55], a[164:167], v[208:211], v[52:55]
    v_add_f32 v99, v99, v15
    v_add_f32 v96, v96, v104
    s_add_u32 s60, s59, s72
    v_mfma_f32_16x16x32_bf16 v[68:71], a[168:171], v[208:211], v[68:71]
    buffer_load_dwordx4 a[240:243], v28, s[36:39], s60 offen offset:0 sc1
    v_mfma_f32_16x16x32_bf16 v[84:87], a[172:175], v[208:211], v[84:87]
    v_add_f32 v97, v97, v105
    s_waitcnt vmcnt(11)
    v_mfma_f32_16x16x32_bf16 v[36:39], a[176:179], v[212:215], v[36:39]
    v_add_f32 v98, v98, v106
    v_add_f32 v99, v99, v107
    v_mfma_f32_16x16x32_bf16 v[52:55], a[180:183], v[212:215], v[52:55]
    v_cvt_pk_bf16_f32 v16, v96, v97
    s_add_u32 s60, s59, s73
    v_mfma_f32_16x16x32_bf16 v[68:71], a[184:187], v[212:215], v[68:71]
    buffer_load_dwordx4 a[244:247], v28, s[36:39], s60 offen offset:0 sc1
    v_mfma_f32_16x16x32_bf16 v[84:87], a[188:191], v[212:215], v[84:87]
    v_cvt_pk_bf16_f32 v17, v98, v99
    s_waitcnt vmcnt(11)
    v_mfma_f32_16x16x32_bf16 v[36:39], a[192:195], v[216:219], v[36:39]
    v_mfma_f32_16x16x32_bf16 v[52:55], a[196:199], v[216:219], v[52:55]
    s_add_u32 s60, s59, s74
    v_mfma_f32_16x16x32_bf16 v[68:71], a[200:203], v[216:219], v[68:71]
    buffer_load_dwordx4 a[248:251], v28, s[36:39], s60 offen offset:0 sc1
    v_mfma_f32_16x16x32_bf16 v[84:87], a[204:207], v[216:219], v[84:87]
    s_waitcnt vmcnt(11)
    v_mfma_f32_16x16x32_bf16 v[36:39], a[208:211], v[220:223], v[36:39]
    v_mfma_f32_16x16x32_bf16 v[52:55], a[212:215], v[220:223], v[52:55]
    s_add_u32 s60, s59, s75
    v_mfma_f32_16x16x32_bf16 v[68:71], a[216:219], v[220:223], v[68:71]
    buffer_load_dwordx4 a[252:255], v28, s[36:39], s60 offen offset:0 sc1
    v_mfma_f32_16x16x32_bf16 v[84:87], a[220:223], v[220:223], v[84:87]
    s_waitcnt vmcnt(11)
    v_mfma_f32_16x16x32_bf16 v[40:43], a[0:3], v[224:227], 0
    v_mfma_f32_16x16x32_bf16 v[56:59], a[4:7], v[224:227], 0
    s_add_u32 s60, s59, s76
    v_mfma_f32_16x16x32_bf16 v[72:75], a[8:11], v[224:227], 0
    buffer_load_dwordx4 v[112:115], v28, s[36:39], s60 offen offset:0 sc1
    v_mfma_f32_16x16x32_bf16 v[88:91], a[12:15], v[224:227], 0
    s_waitcnt vmcnt(11)
    v_mfma_f32_16x16x32_bf16 v[40:43], a[16:19], v[228:231], v[40:43]
    v_mfma_f32_16x16x32_bf16 v[56:59], a[20:23], v[228:231], v[56:59]
    s_add_u32 s60, s59, s77
    v_mfma_f32_16x16x32_bf16 v[72:75], a[24:27], v[228:231], v[72:75]
    buffer_load_dwordx4 v[116:119], v28, s[36:39], s60 offen offset:0 sc1
    v_mfma_f32_16x16x32_bf16 v[88:91], a[28:31], v[228:231], v[88:91]
    s_waitcnt vmcnt(11)
    v_mfma_f32_16x16x32_bf16 v[40:43], a[32:35], v[232:235], v[40:43]
    ds_write_b128 v2, v[36:39] offset:4096
    v_mfma_f32_16x16x32_bf16 v[56:59], a[36:39], v[232:235], v[56:59]
    s_add_u32 s60, s59, s64
    v_mfma_f32_16x16x32_bf16 v[72:75], a[40:43], v[232:235], v[72:75]
    buffer_load_dwordx4 v[120:123], v29, s[36:39], s60 offen offset:0 sc1
    v_mfma_f32_16x16x32_bf16 v[88:91], a[44:47], v[232:235], v[88:91]
    s_waitcnt vmcnt(11)
    v_mfma_f32_16x16x32_bf16 v[40:43], a[48:51], v[236:239], v[40:43]
    ds_write_b128 v3, v[52:55] offset:4096
    v_mfma_f32_16x16x32_bf16 v[56:59], a[52:55], v[236:239], v[56:59]
    s_add_u32 s60, s59, s65
    v_mfma_f32_16x16x32_bf16 v[72:75], a[56:59], v[236:239], v[72:75]
    buffer_load_dwordx4 v[124:127], v29, s[36:39], s60 offen offset:0 sc1
    v_mfma_f32_16x16x32_bf16 v[88:91], a[60:63], v[236:239], v[88:91]
    s_waitcnt vmcnt(11)
    v_mfma_f32_16x16x32_bf16 v[40:43], a[64:67], a[224:227], v[40:43]
    ds_write_b128 v2, v[68:71] offset:4224
    v_mfma_f32_16x16x32_bf16 v[56:59], a[68:71], a[224:227], v[56:59]
    s_add_u32 s60, s59, s66
    v_mfma_f32_16x16x32_bf16 v[72:75], a[72:75], a[224:227], v[72:75]
    buffer_load_dwordx4 v[128:131], v29, s[36:39], s60 offen offset:0 sc1
    v_mfma_f32_16x16x32_bf16 v[88:91], a[76:79], a[224:227], v[88:91]
    s_waitcnt vmcnt(11)
    v_mfma_f32_16x16x32_bf16 v[40:43], a[80:83], a[228:231], v[40:43]
    ds_write_b128 v3, v[84:87] offset:4224
    v_mfma_f32_16x16x32_bf16 v[56:59], a[84:87], a[228:231], v[56:59]
    s_add_u32 s60, s59, s67
    v_mfma_f32_16x16x32_bf16 v[72:75], a[88:91], a[228:231], v[72:75]
    buffer_load_dwordx4 v[132:135], v29, s[36:39], s60 offen offset:0 sc1
    v_mfma_f32_16x16x32_bf16 v[88:91], a[92:95], a[228:231], v[88:91]
    s_waitcnt vmcnt(11)
    v_mfma_f32_16x16x32_bf16 v[40:43], a[96:99], a[232:235], v[40:43]
    v_mfma_f32_16x16x32_bf16 v[56:59], a[100:103], a[232:235], v[56:59]
    s_add_u32 s60, s59, s68
    v_mfma_f32_16x16x32_bf16 v[72:75], a[104:107], a[232:235], v[72:75]
    buffer_load_dwordx4 v[136:139], v29, s[36:39], s60 offen offset:0 sc1
    v_mfma_f32_16x16x32_bf16 v[88:91], a[108:111], a[232:235], v[88:91]
    s_waitcnt lgkmcnt(0)
    s_barrier
    s_waitcnt vmcnt(11)
    v_mfma_f32_16x16x32_bf16 v[40:43], a[112:115], a[236:239], v[40:43]
    ds_read_b128 v[96:99], v6 offset:4096
    ds_read_b128 v[100:103], v6 offset:12288
    v_mfma_f32_16x16x32_bf16 v[56:59], a[116:119], a[236:239], v[56:59]
    ds_read_b128 v[104:107], v6 offset:20480
    ds_read_b128 v[108:111], v6 offset:28672
    s_add_u32 s60, s59, s69
    v_mfma_f32_16x16x32_bf16 v[72:75], a[120:123], a[236:239], v[72:75]
    buffer_load_dwordx4 v[140:143], v29, s[36:39], s60 offen offset:0 sc1
    v_mfma_f32_16x16x32_bf16 v[88:91], a[124:127], a[236:239], v[88:91]
    s_waitcnt lgkmcnt(2)
    s_waitcnt vmcnt(11)
    v_mfma_f32_16x16x32_bf16 v[40:43], a[128:131], a[240:243], v[40:43]
    v_add_f32 v96, v96, v100
    v_add_f32 v97, v97, v101
    v_mfma_f32_16x16x32_bf16 v[56:59], a[132:135], a[240:243], v[56:59]
    v_add_f32 v98, v98, v102
    v_add_f32 v99, v99, v103
    s_add_u32 s60, s59, s70
    v_mfma_f32_16x16x32_bf16 v[72:75], a[136:139], a[240:243], v[72:75]
    buffer_load_dwordx4 v[144:147], v29, s[36:39], s60 offen offset:0 sc1
    v_mfma_f32_16x16x32_bf16 v[88:91], a[140:143], a[240:243], v[88:91]
    s_waitcnt lgkmcnt(0)
    s_waitcnt vmcnt(11)
    v_mfma_f32_16x16x32_bf16 v[40:43], a[144:147], a[244:247], v[40:43]
    v_add_f32 v104, v104, v108
    v_add_f32 v105, v105, v109
    v_mfma_f32_16x16x32_bf16 v[56:59], a[148:151], a[244:247], v[56:59]
    v_add_f32 v106, v106, v110
    v_add_f32 v107, v107, v111
    s_add_u32 s60, s59, s71
    v_mfma_f32_16x16x32_bf16 v[72:75], a[152:155], a[244:247], v[72:75]
    buffer_load_dwordx4 v[148:151], v29, s[36:39], s60 offen offset:0 sc1
    v_mfma_f32_16x16x32_bf16 v[88:91], a[156:159], a[244:247], v[88:91]
    v_add_f32 v96, v96, v12
    s_waitcnt vmcnt(11)
    v_mfma_f32_16x16x32_bf16 v[40:43], a[160:163], a[248:251], v[40:43]
    v_add_f32 v97, v97, v13
    v_add_f32 v98, v98, v14
    v_mfma_f32_16x16x32_bf16 v[56:59], a[164:167], a[248:251], v[56:59]
    v_add_f32 v99, v99, v15
    v_add_f32 v96, v96, v104
    s_add_u32 s60, s59, s72
    v_mfma_f32_16x16x32_bf16 v[72:75], a[168:171], a[248:251], v[72:75]
    buffer_load_dwordx4 v[152:155], v29, s[36:39], s60 offen offset:0 sc1
    v_mfma_f32_16x16x32_bf16 v[88:91], a[172:175], a[248:251], v[88:91]
    v_add_f32 v97, v97, v105
    s_waitcnt vmcnt(11)
    v_mfma_f32_16x16x32_bf16 v[40:43], a[176:179], a[252:255], v[40:43]
    v_add_f32 v98, v98, v106
    v_add_f32 v99, v99, v107
    v_mfma_f32_16x16x32_bf16 v[56:59], a[180:183], a[252:255], v[56:59]
    v_cvt_pk_bf16_f32 v18, v96, v97
    s_add_u32 s60, s59, s73
    v_mfma_f32_16x16x32_bf16 v[72:75], a[184:187], a[252:255], v[72:75]
    buffer_load_dwordx4 v[156:159], v29, s[36:39], s60 offen offset:0 sc1
    v_mfma_f32_16x16x32_bf16 v[88:91], a[188:191], a[252:255], v[88:91]
    v_cvt_pk_bf16_f32 v19, v98, v99
    s_waitcnt vmcnt(11)
    v_mfma_f32_16x16x32_bf16 v[40:43], a[192:195], v[112:115], v[40:43]
    v_mfma_f32_16x16x32_bf16 v[56:59], a[196:199], v[112:115], v[56:59]
    s_add_u32 s60, s59, s74
    v_mfma_f32_16x16x32_bf16 v[72:75], a[200:203], v[112:115], v[72:75]
    buffer_load_dwordx4 v[160:163], v29, s[36:39], s60 offen offset:0 sc1
    v_mfma_f32_16x16x32_bf16 v[88:91], a[204:207], v[112:115], v[88:91]
    s_waitcnt vmcnt(11)
    v_mfma_f32_16x16x32_bf16 v[40:43], a[208:211], v[116:119], v[40:43]
    v_mfma_f32_16x16x32_bf16 v[56:59], a[212:215], v[116:119], v[56:59]
    s_add_u32 s60, s59, s75
    v_mfma_f32_16x16x32_bf16 v[72:75], a[216:219], v[116:119], v[72:75]
    buffer_load_dwordx4 v[164:167], v29, s[36:39], s60 offen offset:0 sc1
    v_mfma_f32_16x16x32_bf16 v[88:91], a[220:223], v[116:119], v[88:91]
    s_waitcnt vmcnt(11)
    v_mfma_f32_16x16x32_bf16 v[44:47], a[0:3], v[120:123], 0
    v_mfma_f32_16x16x32_bf16 v[60:63], a[4:7], v[120:123], 0
    s_add_u32 s60, s59, s76
    v_mfma_f32_16x16x32_bf16 v[76:79], a[8:11], v[120:123], 0
    buffer_load_dwordx4 v[168:171], v29, s[36:39], s60 offen offset:0 sc1
    v_mfma_f32_16x16x32_bf16 v[92:95], a[12:15], v[120:123], 0
    s_waitcnt vmcnt(11)
    v_mfma_f32_16x16x32_bf16 v[44:47], a[16:19], v[124:127], v[44:47]
    v_mfma_f32_16x16x32_bf16 v[60:63], a[20:23], v[124:127], v[60:63]
    s_add_u32 s60, s59, s77
    v_mfma_f32_16x16x32_bf16 v[76:79], a[24:27], v[124:127], v[76:79]
    buffer_load_dwordx4 v[172:175], v29, s[36:39], s60 offen offset:0 sc1
    v_mfma_f32_16x16x32_bf16 v[92:95], a[28:31], v[124:127], v[92:95]
    s_waitcnt vmcnt(11)
    v_mfma_f32_16x16x32_bf16 v[44:47], a[32:35], v[128:131], v[44:47]
    ds_write_b128 v2, v[40:43] offset:32768
    v_mfma_f32_16x16x32_bf16 v[60:63], a[36:39], v[128:131], v[60:63]
    s_add_u32 s53, s58, 0
    buffer_store_dwordx2 v[16:17], v7, s[40:43], s53 offen sc1
    v_mfma_f32_16x16x32_bf16 v[76:79], a[40:43], v[128:131], v[76:79]
    v_mfma_f32_16x16x32_bf16 v[92:95], a[44:47], v[128:131], v[92:95]
    s_waitcnt vmcnt(11)
    v_mfma_f32_16x16x32_bf16 v[44:47], a[48:51], v[132:135], v[44:47]
    ds_write_b128 v3, v[56:59] offset:32768
    v_mfma_f32_16x16x32_bf16 v[60:63], a[52:55], v[132:135], v[60:63]
    s_add_u32 s53, s58, 16384
    buffer_store_dwordx2 v[18:19], v7, s[40:43], s53 offen sc1
    v_mfma_f32_16x16x32_bf16 v[76:79], a[56:59], v[132:135], v[76:79]
    v_mfma_f32_16x16x32_bf16 v[92:95], a[60:63], v[132:135], v[92:95]
    s_waitcnt vmcnt(11)
    v_mfma_f32_16x16x32_bf16 v[44:47], a[64:67], v[136:139], v[44:47]
    ds_write_b128 v2, v[72:75] offset:32896
    v_mfma_f32_16x16x32_bf16 v[60:63], a[68:71], v[136:139], v[60:63]
    v_mfma_f32_16x16x32_bf16 v[76:79], a[72:75], v[136:139], v[76:79]
    v_mfma_f32_16x16x32_bf16 v[92:95], a[76:79], v[136:139], v[92:95]
    s_waitcnt vmcnt(10)
    v_mfma_f32_16x16x32_bf16 v[44:47], a[80:83], v[140:143], v[44:47]
    ds_write_b128 v3, v[88:91] offset:32896
    v_mfma_f32_16x16x32_bf16 v[60:63], a[84:87], v[140:143], v[60:63]
    v_mfma_f32_16x16x32_bf16 v[76:79], a[88:91], v[140:143], v[76:79]
    v_mfma_f32_16x16x32_bf16 v[92:95], a[92:95], v[140:143], v[92:95]
    s_waitcnt vmcnt(9)
    v_mfma_f32_16x16x32_bf16 v[44:47], a[96:99], v[144:147], v[44:47]
    v_mfma_f32_16x16x32_bf16 v[60:63], a[100:103], v[144:147], v[60:63]
    v_mfma_f32_16x16x32_bf16 v[76:79], a[104:107], v[144:147], v[76:79]
    s_waitcnt lgkmcnt(0)
    s_barrier
    v_mfma_f32_16x16x32_bf16 v[92:95], a[108:111], v[144:147], v[92:95]
    ds_read_b128 v[96:99], v6 offset:32768
    s_waitcnt vmcnt(8)
    v_mfma_f32_16x16x32_bf16 v[44:47], a[112:115], v[148:151], v[44:47]
    ds_read_b128 v[100:103], v6 offset:40960
    ds_read_b128 v[104:107], v6 offset:49152
    v_mfma_f32_16x16x32_bf16 v[60:63], a[116:119], v[148:151], v[60:63]
    ds_read_b128 v[108:111], v6 offset:57344
    v_mfma_f32_16x16x32_bf16 v[76:79], a[120:123], v[148:151], v[76:79]
    s_waitcnt lgkmcnt(2)
    v_add_f32 v96, v96, v100
    v_mfma_f32_16x16x32_bf16 v[92:95], a[124:127], v[148:151], v[92:95]
    v_add_f32 v97, v97, v101
    s_waitcnt vmcnt(7)
    v_mfma_f32_16x16x32_bf16 v[44:47], a[128:131], v[152:155], v[44:47]
    v_add_f32 v98, v98, v102
    v_add_f32 v99, v99, v103
    v_mfma_f32_16x16x32_bf16 v[60:63], a[132:135], v[152:155], v[60:63]
    s_waitcnt lgkmcnt(0)
    v_add_f32 v104, v104, v108
    v_mfma_f32_16x16x32_bf16 v[76:79], a[136:139], v[152:155], v[76:79]
    v_add_f32 v105, v105, v109
    v_add_f32 v106, v106, v110
    v_mfma_f32_16x16x32_bf16 v[92:95], a[140:143], v[152:155], v[92:95]
    v_add_f32 v107, v107, v111
    s_waitcnt vmcnt(6)
    v_mfma_f32_16x16x32_bf16 v[44:47], a[144:147], v[156:159], v[44:47]
    v_add_f32 v96, v96, v12
    v_add_f32 v97, v97, v13
    v_mfma_f32_16x16x32_bf16 v[60:63], a[148:151], v[156:159], v[60:63]
    v_add_f32 v98, v98, v14
    v_add_f32 v99, v99, v15
    v_mfma_f32_16x16x32_bf16 v[76:79], a[152:155], v[156:159], v[76:79]
    v_add_f32 v96, v96, v104
    v_add_f32 v97, v97, v105
    v_mfma_f32_16x16x32_bf16 v[92:95], a[156:159], v[156:159], v[92:95]
    v_add_f32 v98, v98, v106
    s_waitcnt vmcnt(5)
    v_mfma_f32_16x16x32_bf16 v[44:47], a[160:163], v[160:163], v[44:47]
    v_add_f32 v99, v99, v107
    v_mfma_f32_16x16x32_bf16 v[60:63], a[164:167], v[160:163], v[60:63]
    v_cvt_pk_bf16_f32 v20, v96, v97
    v_mfma_f32_16x16x32_bf16 v[76:79], a[168:171], v[160:163], v[76:79]
    v_cvt_pk_bf16_f32 v21, v98, v99
    v_mfma_f32_16x16x32_bf16 v[92:95], a[172:175], v[160:163], v[92:95]
    s_waitcnt vmcnt(4)
    v_mfma_f32_16x16x32_bf16 v[44:47], a[176:179], v[164:167], v[44:47]
    v_mfma_f32_16x16x32_bf16 v[60:63], a[180:183], v[164:167], v[60:63]
    s_add_u32 s53, s58, 32768
    buffer_store_dwordx2 v[20:21], v7, s[40:43], s53 offen sc1
    v_mfma_f32_16x16x32_bf16 v[76:79], a[184:187], v[164:167], v[76:79]
    v_mfma_f32_16x16x32_bf16 v[92:95], a[188:191], v[164:167], v[92:95]
    s_waitcnt vmcnt(4)
    v_mfma_f32_16x16x32_bf16 v[44:47], a[192:195], v[168:171], v[44:47]
    v_mfma_f32_16x16x32_bf16 v[60:63], a[196:199], v[168:171], v[60:63]
    v_mfma_f32_16x16x32_bf16 v[76:79], a[200:203], v[168:171], v[76:79]
    v_mfma_f32_16x16x32_bf16 v[92:95], a[204:207], v[168:171], v[92:95]
    s_waitcnt vmcnt(3)
    v_mfma_f32_16x16x32_bf16 v[44:47], a[208:211], v[172:175], v[44:47]
    v_mfma_f32_16x16x32_bf16 v[60:63], a[212:215], v[172:175], v[60:63]
    v_mfma_f32_16x16x32_bf16 v[76:79], a[216:219], v[172:175], v[76:79]
    v_mfma_f32_16x16x32_bf16 v[92:95], a[220:223], v[172:175], v[92:95]
    s_nop 4
    ds_write_b128 v2, v[44:47] offset:36864
    ds_write_b128 v3, v[60:63] offset:36864
    ds_write_b128 v2, v[76:79] offset:36992
    ds_write_b128 v3, v[92:95] offset:36992
    s_add_u32 s53, s58, 49152
    s_waitcnt lgkmcnt(0)
    s_barrier
    ds_read_b128 v[96:99], v6 offset:36864
    ds_read_b128 v[100:103], v6 offset:45056
    ds_read_b128 v[104:107], v6 offset:53248
    ds_read_b128 v[108:111], v6 offset:61440
    s_waitcnt lgkmcnt(3)
    v_pk_add_f32 v[96:97], v[96:97], v[12:13]
    v_pk_add_f32 v[98:99], v[98:99], v[14:15]
    s_waitcnt lgkmcnt(2)
    v_pk_add_f32 v[96:97], v[96:97], v[100:101]
    v_pk_add_f32 v[98:99], v[98:99], v[102:103]
    s_waitcnt lgkmcnt(1)
    v_pk_add_f32 v[96:97], v[96:97], v[104:105]
    v_pk_add_f32 v[98:99], v[98:99], v[106:107]
    s_waitcnt lgkmcnt(0)
    v_pk_add_f32 v[96:97], v[96:97], v[108:109]
    v_pk_add_f32 v[98:99], v[98:99], v[110:111]
    v_cvt_pk_bf16_f32 v22, v96, v97
    v_cvt_pk_bf16_f32 v23, v98, v99
    buffer_store_dwordx2 v[22:23], v7, s[40:43], s53 offen sc1
L_end:
    s_endpgm
.section .rodata,"a"
.p2align 6
.amdhsa_kernel standalone__dense_activation_squared_relu__prompt_kernel
  .amdhsa_next_free_vgpr 512
  .amdhsa_next_free_sgpr 102
  .amdhsa_accum_offset 256
  .amdhsa_group_segment_fixed_size 0
  .amdhsa_kernarg_size 64
  .amdhsa_user_sgpr_count 2
  .amdhsa_user_sgpr_kernarg_segment_ptr 1
  .amdhsa_system_sgpr_workgroup_id_x 1
  .amdhsa_float_denorm_mode_32 3
  .amdhsa_float_denorm_mode_16_64 3
.end_amdhsa_kernel
```
